```python
import torch

def _softmax(x, axis=-1):
    return torch.softmax(x, dim=axis)
def _gelu(x):
    return torch.nn.functional.gelu(x, approximate="tanh")
def _silu(x):
    return torch.nn.functional.silu(x)
def _sigmoid(x):
    return torch.sigmoid(x)
def _layernorm(x, axis=-1, eps=1e-5):
    m = x.mean(dim=axis, keepdim=True)
    v = x.var(dim=axis, keepdim=True, unbiased=False)
    return (x - m) / torch.sqrt(v + eps)
def _scatter_add(tgt, idx, src, axis=0):
    return tgt.clone().index_add_(axis, idx, src)
def _segment_sum(src, seg, n):
    out = torch.zeros((n,) + src.shape[1:], dtype=src.dtype)
    return out.index_add_(0, seg, src)
def _pad(x, pw):
    flat = tuple(v for pair in reversed(pw) for v in pair)
    return torch.nn.functional.pad(x, flat)

kernel_name = 'interleave_layers__gqa_block_cached__glu_gated_glu__decode'

def setup_inputs():

    _w = (lambda a: (lambda t: t.to(torch.bfloat16) if t.is_floating_point() else t)(torch.as_tensor(a)))
    def _A_setup():
        B, Sq, D = 1, 1, 512
        Hq, Hkv, Sk, Dh = 32, 32, 16384, 128
        assert Hq % Hkv == 0, (Hq, Hkv)
        return {
            "x": _w((lambda *s: torch.randn(*s, dtype=torch.bfloat16) * 0.05)(B, Sq, D)),
            "k_cache": _w((lambda *s: torch.randn(*s, dtype=torch.bfloat16) * 1.6)(B, Hkv, Sk, Dh)),
            "v_cache": _w((lambda *s: torch.randn(*s, dtype=torch.bfloat16) * 1.6)(B, Hkv, Sk, Dh)),
            "wq": _w((lambda *s: torch.randn(*s, dtype=torch.bfloat16) * 1.6)(D, Hq * Dh) * (D ** -0.5)),
            "wo": _w((lambda *s: torch.randn(*s, dtype=torch.bfloat16) * 1.6)(Hq * Dh, D) * ((Hq * Dh) ** -0.5)),
        }
    _A_in = _A_setup()

    def _B_setup():
        B, S, D, F = 1, 1, 512, 1376
        return {
            "x": _w((lambda *s: torch.randn(*s, dtype=torch.bfloat16) * 0.05)(B, S, D)),
            "w_gate": _w((lambda *s: torch.randn(*s, dtype=torch.bfloat16) * 0.05)(D, F)),
            "w_up": _w((lambda *s: torch.randn(*s, dtype=torch.bfloat16) * 0.05)(D, F)),
            "w_down": _w((lambda *s: torch.randn(*s, dtype=torch.bfloat16) * 0.05)(F, D)),
        }
    _B_in = _B_setup()

    return {
        "A_x": _A_in["x"],
        "A_k_cache": _A_in["k_cache"],
        "A_v_cache": _A_in["v_cache"],
        "A_wq": _A_in["wq"],
        "A_wo": _A_in["wo"],
        "B_x": _B_in["x"],
        "B_w_gate": _B_in["w_gate"],
        "B_w_up": _B_in["w_up"],
        "B_w_down": _B_in["w_down"],
    }

def reference(A_x, A_k_cache, A_v_cache, A_wq, A_wo, B_x, B_w_gate, B_w_up, B_w_down):
    def _A_ref(x, k_cache, v_cache, wq, wo):
        B, Sq, D = x.shape
        Hq, Dh = 32, 128
        Hkv = k_cache.shape[1]
        rep = Hq // Hkv
        q = (lambda x, *d: x.permute(*d))((x @ wq).reshape(B, Sq, Hq, Dh), 0, 2, 1, 3)
        k = (lambda x, n, axis: torch.repeat_interleave(x, n, dim=axis))(k_cache, rep, axis=1)
        v = (lambda x, n, axis: torch.repeat_interleave(x, n, dim=axis))(v_cache, rep, axis=1)
        scores = torch.einsum("bhqd,bhkd->bhqk", q, k) * (Dh ** -0.5)
        p = _softmax(scores, axis=-1)
        o = torch.einsum("bhqk,bhkd->bhqd", p, v)
        return (lambda x, *d: x.permute(*d))(o, 0, 2, 1, 3).reshape(B, Sq, Hq * Dh) @ wo

    def _B_ref(x, w_gate, w_up, w_down):
        g = torch.einsum("bsd,df->bsf", x, w_gate)
        u = torch.einsum("bsd,df->bsf", x, w_up)
        h = _sigmoid(g) * u
        return torch.einsum("bsf,fd->bsd", h, w_down)

    x = A_x
    x = x + _A_ref(_layernorm(x, axis=-1), A_k_cache, A_v_cache, A_wq, A_wo)
    x = x + _B_ref(_layernorm(x, axis=-1), B_w_gate, B_w_up, B_w_down)
    x = x + _A_ref(_layernorm(x, axis=-1), A_k_cache, A_v_cache, A_wq, A_wo)
    x = x + _B_ref(_layernorm(x, axis=-1), B_w_gate, B_w_up, B_w_down)
    return x
```

```asm
; @launch grid=(256,1,1) block=(256,1,1) lds=159744
.amdgcn_target "amdgcn-amd-amdhsa--gfx950"
.text
.globl interleave_layers__gqa_block_cached__glu_gated_glu__decode_kernel
.p2align 8
.type interleave_layers__gqa_block_cached__glu_gated_glu__decode_kernel,@function
interleave_layers__gqa_block_cached__glu_gated_glu__decode_kernel:
    s_cmp_ge_u32 s2, 256
    s_cbranch_scc1 L_END
    s_load_dwordx16 s[84:99], s[0:1], 0
    s_load_dwordx8 s[72:79], s[0:1], 64
    v_and_b32 v1, 63, v0
    v_lshrrev_b32 v13, 6, v0
    s_lshr_b32 s4, s2, 3
    s_and_b32 s5, s2, 7
    v_readfirstlane_b32 s3, v13
    v_bfe_u32 v9, v0, 1, 3
    v_lshlrev_b32 v9, 8, v9
    v_bfe_u32 v15, v0, 4, 2
    v_lshl_add_u32 v9, v15, 5, v9
    v_and_b32 v15, 1, v0
    v_lshl_add_u32 v9, v15, 4, v9
    s_lshl_b32 s60, s4, 22
    s_mul_i32 s68, s5, 409600
    s_add_u32 s60, s60, s68
    s_lshl_b32 s68, s3, 12
    s_add_u32 s60, s60, s68
    s_waitcnt lgkmcnt(0)
    s_mov_b32 s8, s86
    s_mov_b32 s9, s87
    s_mov_b32 s10, 0x8000000
    s_mov_b32 s11, 0x00020000
    s_add_u32 s61, s60, 0
    s_waitcnt vmcnt(7)
    buffer_load_dwordx4 a[0:3], v9, s[8:11], s61 offen offset:0 nt
    s_waitcnt vmcnt(7)
    buffer_load_dwordx4 a[4:7], v9, s[8:11], s61 offen offset:128 nt
    s_waitcnt vmcnt(7)
    buffer_load_dwordx4 a[8:11], v9, s[8:11], s61 offen offset:2048 nt
    s_waitcnt vmcnt(7)
    buffer_load_dwordx4 a[12:15], v9, s[8:11], s61 offen offset:2176 nt
    s_add_u32 s61, s60, 16384
    s_waitcnt vmcnt(7)
    buffer_load_dwordx4 a[16:19], v9, s[8:11], s61 offen offset:0 nt
    s_waitcnt vmcnt(7)
    buffer_load_dwordx4 a[20:23], v9, s[8:11], s61 offen offset:128 nt
    s_waitcnt vmcnt(7)
    buffer_load_dwordx4 a[24:27], v9, s[8:11], s61 offen offset:2048 nt
    s_waitcnt vmcnt(7)
    buffer_load_dwordx4 a[28:31], v9, s[8:11], s61 offen offset:2176 nt
    s_mov_b32 s40, s84
    s_mov_b32 s41, s85
    s_mov_b32 s42, 0x400
    s_mov_b32 s43, 0x00020000
    s_mov_b32 s12, s88
    s_mov_b32 s13, s89
    s_mov_b32 s14, 0x8000000
    s_mov_b32 s15, 0x00020000
    s_mov_b32 s20, s90
    s_mov_b32 s21, s91
    s_mov_b32 s22, 0x400000
    s_mov_b32 s23, 0x00020000
    s_mov_b32 s24, s92
    s_mov_b32 s25, s93
    s_mov_b32 s26, 0x400000
    s_mov_b32 s27, 0x00020000
    s_mov_b32 s28, s96
    s_mov_b32 s29, s97
    s_mov_b32 s30, 0x158000
    s_mov_b32 s31, 0x00020000
    s_mov_b32 s32, s98
    s_mov_b32 s33, s99
    s_mov_b32 s34, 0x158000
    s_mov_b32 s35, 0x00020000
    s_mov_b32 s36, s72
    s_mov_b32 s37, s73
    s_mov_b32 s38, 0x158000
    s_mov_b32 s39, 0x00020000
    s_mov_b32 s44, s74
    s_mov_b32 s45, s75
    s_mov_b32 s46, 0x400
    s_mov_b32 s47, 0x00020000
    s_mov_b32 s48, s76
    s_mov_b32 s49, s77
    s_mov_b32 s50, 0x100
    s_mov_b32 s51, 0x00020000
    s_mov_b32 s16, s78
    s_mov_b32 s17, s79
    s_mov_b32 s18, 0x200000
    s_mov_b32 s19, 0x00020000
    s_mov_b32 s52, 0x55555555
    s_mov_b32 s53, 0x55555555
    s_mov_b32 s54, 0x00010001
    s_mov_b32 s55, 0x00010001
    s_mov_b32 s56, 0x00ff00ff
    s_mov_b32 s57, 0x00ff00ff
    s_mov_b32 s58, 0xff00ff00
    s_mov_b32 s59, 0xff00ff00
    s_mov_b32 s66, 0x3e0293ee
    s_mov_b32 s67, 0x3f80
    s_mov_b32 s74, 0x3f800000
    s_mov_b32 s65, 200000
    s_mov_b32 s62, 0
    s_lshl_b32 s70, s4, 13
    s_lshl_b32 s71, s5, 18
    s_add_u32 s63, s70, s71
    s_mov_b32 s90, 0x33333333
    s_mov_b32 s91, 0x33333333
    s_mov_b32 s92, 0x0f0f0f0f
    s_mov_b32 s93, 0x0f0f0f0f
    s_mov_b32 s94, 0x00550055
    s_mov_b32 s95, 0x00550055
    s_lshl_b32 s99, s4, 22
    s_add_u32 s99, s99, 3276800
    s_mul_i32 s68, s4, 43
    s_add_u32 s69, s68, 43
    s_lshr_b32 s68, s68, 3
    s_lshr_b32 s69, s69, 3
    s_sub_u32 s73, s69, s68
    s_lshl_b32 s73, s73, 3
    s_lshl_b32 s72, s68, 3
    s_lshl_b32 s68, s5, 6
    s_lshl_b32 s69, s3, 4
    s_add_u32 s68, s68, s69
    s_lshl_b32 s75, s68, 13
    s_lshl_b32 s69, s4, 8
    s_add_u32 s75, s75, s69
    s_mul_i32 s77, s68, 2752
    s_lshl_b32 s69, s72, 1
    s_add_u32 s77, s77, s69
    s_lshl_b32 s76, s4, 17
    s_lshl_b32 s69, s3, 15
    s_add_u32 s76, s76, s69
    s_lshl_b32 s69, s5, 7
    s_add_u32 s76, s76, s69
    s_lshl_b32 s78, s3, 2
    s_add_u32 s78, s78, s72
    s_lshl_b32 s78, s78, 10
    s_lshl_b32 s69, s5, 7
    s_add_u32 s78, s78, s69
    v_lshrrev_b32 v13, 4, v1
    v_and_b32 v14, 15, v1
    v_lshlrev_b32 v2, 9, v13
    v_lshl_add_u32 v2, v14, 4, v2
    s_mul_i32 s69, s3, 36864
    s_add_u32 s69, s69, 12288
    v_lshlrev_b32 v3, 4, v1
    v_add_u32 v3, s69, v3
    s_lshl_b32 s69, s3, 11
    v_lshlrev_b32 v8, 4, v13
    v_add_u32 v8, s69, v8
    s_lshl_b32 s69, s3, 6
    v_lshlrev_b32 v10, 13, v13
    v_lshl_add_u32 v10, v14, 2, v10
    v_add_u32 v10, s69, v10
    v_mov_b32 v16, -1
    v_mov_b32 v17, -1
    v_mov_b32 v18, -1
    v_mov_b32 v19, -1
    v_lshlrev_b32 v15, 4, v0
    s_add_u32 s69, s63, 4096
    buffer_store_dwordx4 v[16:19], v15, s[16:19], s69 offen sc1
    s_getreg_b32 s6, hwreg(HW_REG_XCC_ID)
    s_and_b32 s6, s6, 15
    s_mov_b32 s7, 0
    v_mov_b32 v21, -1
    v_mov_b32 v22, -1
    v_mov_b32 v23, -1
    v_mov_b32 v24, s6
    v_cmp_eq_u32 vcc, 248, v0
    s_nop 1
    v_cndmask_b32 v20, -1, v24, vcc
    buffer_store_dwordx4 v[20:23], v15, s[16:19], s63 offen sc1
    v_lshlrev_b32 v15, 3, v13
    s_lshl_b32 s69, s68, 1
    buffer_load_dwordx2 v[48:49], v15, s[40:43], s69 offen nt
    v_lshrrev_b32 v50, 4, v1
    v_lshlrev_b32 v50, 15, v50
    v_and_b32 v15, 15, v1
    v_lshl_add_u32 v50, v15, 4, v50
    s_add_u32 s69, s75, 0
    buffer_load_dwordx4 v[96:99], v50, s[20:23], s69 offen
    s_add_u32 s69, s75, 8192
    buffer_load_dwordx4 v[100:103], v50, s[20:23], s69 offen
    s_add_u32 s69, s75, 16384
    buffer_load_dwordx4 v[104:107], v50, s[20:23], s69 offen
    s_add_u32 s69, s75, 24576
    buffer_load_dwordx4 v[108:111], v50, s[20:23], s69 offen
    s_add_u32 s61, s60, 32768
    s_waitcnt vmcnt(7)
    buffer_load_dwordx4 a[32:35], v9, s[8:11], s61 offen offset:0 nt
    s_waitcnt vmcnt(7)
    buffer_load_dwordx4 a[36:39], v9, s[8:11], s61 offen offset:128 nt
    s_waitcnt vmcnt(7)
    buffer_load_dwordx4 a[40:43], v9, s[8:11], s61 offen offset:2048 nt
    s_waitcnt vmcnt(7)
    buffer_load_dwordx4 a[44:47], v9, s[8:11], s61 offen offset:2176 nt
    s_add_u32 s61, s60, 49152
    s_waitcnt vmcnt(7)
    buffer_load_dwordx4 a[48:51], v9, s[8:11], s61 offen offset:0 nt
    s_waitcnt vmcnt(7)
    buffer_load_dwordx4 a[52:55], v9, s[8:11], s61 offen offset:128 nt
    s_waitcnt vmcnt(7)
    buffer_load_dwordx4 a[56:59], v9, s[8:11], s61 offen offset:2048 nt
    s_waitcnt vmcnt(7)
    buffer_load_dwordx4 a[60:63], v9, s[8:11], s61 offen offset:2176 nt
    s_add_u32 s61, s60, 65536
    s_waitcnt vmcnt(7)
    buffer_load_dwordx4 a[64:67], v9, s[8:11], s61 offen offset:0 nt
    s_waitcnt vmcnt(7)
    buffer_load_dwordx4 a[68:71], v9, s[8:11], s61 offen offset:128 nt
    s_waitcnt vmcnt(7)
    buffer_load_dwordx4 a[72:75], v9, s[8:11], s61 offen offset:2048 nt
    s_waitcnt vmcnt(7)
    buffer_load_dwordx4 a[76:79], v9, s[8:11], s61 offen offset:2176 nt
    s_add_u32 s61, s60, 81920
    s_waitcnt vmcnt(7)
    buffer_load_dwordx4 a[80:83], v9, s[8:11], s61 offen offset:0 nt
    s_waitcnt vmcnt(7)
    buffer_load_dwordx4 a[84:87], v9, s[8:11], s61 offen offset:128 nt
    s_waitcnt vmcnt(7)
    buffer_load_dwordx4 a[88:91], v9, s[8:11], s61 offen offset:2048 nt
    s_waitcnt vmcnt(7)
    buffer_load_dwordx4 a[92:95], v9, s[8:11], s61 offen offset:2176 nt
    s_add_u32 s61, s60, 98304
    s_waitcnt vmcnt(7)
    buffer_load_dwordx4 a[96:99], v9, s[8:11], s61 offen offset:0 nt
    s_waitcnt vmcnt(7)
    buffer_load_dwordx4 a[100:103], v9, s[8:11], s61 offen offset:128 nt
    s_waitcnt vmcnt(7)
    buffer_load_dwordx4 a[104:107], v9, s[8:11], s61 offen offset:2048 nt
    s_waitcnt vmcnt(7)
    buffer_load_dwordx4 a[108:111], v9, s[8:11], s61 offen offset:2176 nt
    s_add_u32 s61, s60, 114688
    s_waitcnt vmcnt(7)
    buffer_load_dwordx4 a[112:115], v9, s[8:11], s61 offen offset:0 nt
    s_waitcnt vmcnt(7)
    buffer_load_dwordx4 a[116:119], v9, s[8:11], s61 offen offset:128 nt
    s_waitcnt vmcnt(7)
    buffer_load_dwordx4 a[120:123], v9, s[8:11], s61 offen offset:2048 nt
    s_waitcnt vmcnt(7)
    buffer_load_dwordx4 a[124:127], v9, s[8:11], s61 offen offset:2176 nt
    s_waitcnt vmcnt(24)
    v_lshlrev_b32 v4, 16, v48
    v_and_b32 v5, 0xffff0000, v48
    v_lshlrev_b32 v6, 16, v49
    v_and_b32 v7, 0xffff0000, v49
    v_dot2_f32_bf16 v32, v96, s67, 0
    v_dot2_f32_bf16 v33, v96, s74, 0
    v_dot2_f32_bf16 v34, v97, s67, 0
    v_dot2_f32_bf16 v35, v97, s74, 0
    v_dot2_f32_bf16 v36, v98, s67, 0
    v_dot2_f32_bf16 v37, v98, s74, 0
    v_dot2_f32_bf16 v38, v99, s67, 0
    v_dot2_f32_bf16 v39, v99, s74, 0
    v_dot2_f32_bf16 v32, v100, s67, v32
    v_dot2_f32_bf16 v33, v100, s74, v33
    v_dot2_f32_bf16 v34, v101, s67, v34
    v_dot2_f32_bf16 v35, v101, s74, v35
    v_dot2_f32_bf16 v36, v102, s67, v36
    v_dot2_f32_bf16 v37, v102, s74, v37
    v_dot2_f32_bf16 v38, v103, s67, v38
    v_dot2_f32_bf16 v39, v103, s74, v39
    v_dot2_f32_bf16 v32, v104, s67, v32
    v_dot2_f32_bf16 v33, v104, s74, v33
    v_dot2_f32_bf16 v34, v105, s67, v34
    v_dot2_f32_bf16 v35, v105, s74, v35
    v_dot2_f32_bf16 v36, v106, s67, v36
    v_dot2_f32_bf16 v37, v106, s74, v37
    v_dot2_f32_bf16 v38, v107, s67, v38
    v_dot2_f32_bf16 v39, v107, s74, v39
    v_dot2_f32_bf16 v32, v108, s67, v32
    v_dot2_f32_bf16 v33, v108, s74, v33
    v_dot2_f32_bf16 v34, v109, s67, v34
    v_dot2_f32_bf16 v35, v109, s74, v35
    v_dot2_f32_bf16 v36, v110, s67, v36
    v_dot2_f32_bf16 v37, v110, s74, v37
    v_dot2_f32_bf16 v38, v111, s67, v38
    v_dot2_f32_bf16 v39, v111, s74, v39
    s_nop 2
    v_permlane16_swap_b32 v32, v33
    v_permlane16_swap_b32 v34, v35
    v_add_f32 v32, v32, v33
    v_add_f32 v34, v34, v35
    s_nop 1
    v_permlane32_swap_b32 v32, v34
    v_add_f32 v32, v32, v34
    s_nop 2
    v_permlane16_swap_b32 v36, v37
    v_permlane16_swap_b32 v38, v39
    v_add_f32 v36, v36, v37
    v_add_f32 v38, v38, v39
    s_nop 1
    v_permlane32_swap_b32 v36, v38
    v_add_f32 v36, v36, v38
    v_and_b32 v13, 15, v1
    v_lshlrev_b32 v13, 5, v13
    v_lshrrev_b32 v15, 4, v1
    v_lshl_add_u32 v13, v15, 2, v13
    s_lshl_b32 s69, s3, 11
    v_add_u32 v13, s69, v13
    ds_write_b32 v13, v32 offset:512
    ds_write_b32 v13, v36 offset:528
    v_cvt_pk_bf16_f32 v24, v4, 0
    v_and_b32 v25, 0xffff0000, v4
    v_cvt_pk_bf16_f32 v26, v5, 0
    v_and_b32 v27, 0xffff0000, v5
    v_cvt_pk_bf16_f32 v28, v6, 0
    v_and_b32 v29, 0xffff0000, v6
    v_cvt_pk_bf16_f32 v30, v7, 0
    v_and_b32 v31, 0xffff0000, v7
    v_dot2_f32_bf16 v16, v96, v24, 0
    v_dot2_f32_bf16 v17, v96, v25, 0
    v_dot2_f32_bf16 v18, v97, v24, 0
    v_dot2_f32_bf16 v19, v97, v25, 0
    v_dot2_f32_bf16 v20, v98, v24, 0
    v_dot2_f32_bf16 v21, v98, v25, 0
    v_dot2_f32_bf16 v22, v99, v24, 0
    v_dot2_f32_bf16 v23, v99, v25, 0
    v_dot2_f32_bf16 v16, v100, v26, v16
    v_dot2_f32_bf16 v17, v100, v27, v17
    v_dot2_f32_bf16 v18, v101, v26, v18
    v_dot2_f32_bf16 v19, v101, v27, v19
    v_dot2_f32_bf16 v20, v102, v26, v20
    v_dot2_f32_bf16 v21, v102, v27, v21
    v_dot2_f32_bf16 v22, v103, v26, v22
    v_dot2_f32_bf16 v23, v103, v27, v23
    v_dot2_f32_bf16 v16, v104, v28, v16
    v_dot2_f32_bf16 v17, v104, v29, v17
    v_dot2_f32_bf16 v18, v105, v28, v18
    v_dot2_f32_bf16 v19, v105, v29, v19
    v_dot2_f32_bf16 v20, v106, v28, v20
    v_dot2_f32_bf16 v21, v106, v29, v21
    v_dot2_f32_bf16 v22, v107, v28, v22
    v_dot2_f32_bf16 v23, v107, v29, v23
    v_dot2_f32_bf16 v16, v108, v30, v16
    v_dot2_f32_bf16 v17, v108, v31, v17
    v_dot2_f32_bf16 v18, v109, v30, v18
    v_dot2_f32_bf16 v19, v109, v31, v19
    v_dot2_f32_bf16 v20, v110, v30, v20
    v_dot2_f32_bf16 v21, v110, v31, v21
    v_dot2_f32_bf16 v22, v111, v30, v22
    v_dot2_f32_bf16 v23, v111, v31, v23
    s_nop 2
    v_permlane16_swap_b32 v16, v17
    v_permlane16_swap_b32 v18, v19
    v_add_f32 v16, v16, v17
    v_add_f32 v18, v18, v19
    s_nop 1
    v_permlane32_swap_b32 v16, v18
    v_add_f32 v16, v16, v18
    s_nop 2
    v_permlane16_swap_b32 v20, v21
    v_permlane16_swap_b32 v22, v23
    v_add_f32 v20, v20, v21
    v_add_f32 v22, v22, v23
    s_nop 1
    v_permlane32_swap_b32 v20, v22
    v_add_f32 v20, v20, v22
    v_and_b32 v13, 15, v1
    v_lshlrev_b32 v13, 5, v13
    v_lshrrev_b32 v15, 4, v1
    v_lshl_add_u32 v13, v15, 2, v13
    s_lshl_b32 s69, s3, 11
    v_add_u32 v13, s69, v13
    ds_write_b32 v13, v16
    ds_write_b32 v13, v20 offset:16
    s_add_u32 s61, s60, 131072
    s_waitcnt vmcnt(7)
    buffer_load_dwordx4 a[128:131], v9, s[8:11], s61 offen offset:0 nt
    s_waitcnt vmcnt(7)
    buffer_load_dwordx4 a[132:135], v9, s[8:11], s61 offen offset:128 nt
    s_waitcnt vmcnt(7)
    buffer_load_dwordx4 a[136:139], v9, s[8:11], s61 offen offset:2048 nt
    s_waitcnt vmcnt(7)
    buffer_load_dwordx4 a[140:143], v9, s[8:11], s61 offen offset:2176 nt
    s_add_u32 s61, s60, 147456
    s_waitcnt vmcnt(7)
    buffer_load_dwordx4 a[144:147], v9, s[8:11], s61 offen offset:0 nt
    s_waitcnt vmcnt(7)
    buffer_load_dwordx4 a[148:151], v9, s[8:11], s61 offen offset:128 nt
    s_waitcnt vmcnt(7)
    buffer_load_dwordx4 a[152:155], v9, s[8:11], s61 offen offset:2048 nt
    s_waitcnt vmcnt(7)
    buffer_load_dwordx4 a[156:159], v9, s[8:11], s61 offen offset:2176 nt
    s_add_u32 s61, s60, 163840
    s_waitcnt vmcnt(7)
    buffer_load_dwordx4 a[160:163], v9, s[8:11], s61 offen offset:0 nt
    s_waitcnt vmcnt(7)
    buffer_load_dwordx4 a[164:167], v9, s[8:11], s61 offen offset:128 nt
    s_waitcnt vmcnt(7)
    buffer_load_dwordx4 a[168:171], v9, s[8:11], s61 offen offset:2048 nt
    s_waitcnt vmcnt(7)
    buffer_load_dwordx4 a[172:175], v9, s[8:11], s61 offen offset:2176 nt
    s_add_u32 s61, s60, 180224
    s_waitcnt vmcnt(7)
    buffer_load_dwordx4 a[176:179], v9, s[8:11], s61 offen offset:0 nt
    s_waitcnt vmcnt(7)
    buffer_load_dwordx4 a[180:183], v9, s[8:11], s61 offen offset:128 nt
    s_waitcnt vmcnt(7)
    buffer_load_dwordx4 a[184:187], v9, s[8:11], s61 offen offset:2048 nt
    s_waitcnt vmcnt(7)
    buffer_load_dwordx4 a[188:191], v9, s[8:11], s61 offen offset:2176 nt
    s_waitcnt lgkmcnt(0)
    s_barrier
    s_cmp_lg_u32 s3, 0
    s_cbranch_scc1 L_1
    v_mov_b32 v15, 1
    s_mov_b64 exec, 1
    buffer_atomic_add v15, off, s[48:51], 0 sc1
    s_mov_b64 exec, -1
L_1:
    v_lshrrev_b32 v13, 4, v1
    v_lshlrev_b32 v13, 4, v13
    s_lshl_b32 s69, s3, 6
    s_add_u32 s69, s69, s63
    s_add_u32 s69, s69, s62
    s_mov_b64 exec, s[54:55]
    buffer_store_dwordx4 v[4:7], v13, s[16:19], s69 offen offset:1024 sc1
    s_mov_b64 exec, -1
    s_add_u32 s69, s63, s62
    s_cmp_ge_u32 s3, 2
    s_cbranch_scc1 L_2
    v_lshlrev_b32 v13, 2, v0
    ds_read_b32 v16, v13 offset:0
    ds_read_b32 v20, v13 offset:512
    ds_read_b32 v17, v13 offset:2048
    ds_read_b32 v21, v13 offset:2560
    ds_read_b32 v18, v13 offset:4096
    ds_read_b32 v22, v13 offset:4608
    ds_read_b32 v19, v13 offset:6144
    ds_read_b32 v23, v13 offset:6656
    v_lshlrev_b32 v13, 3, v0
    s_waitcnt lgkmcnt(0)
    v_add_f32 v16, v16, v17
    v_add_f32 v18, v18, v19
    v_add_f32 v24, v16, v18
    v_add_f32 v20, v20, v21
    v_add_f32 v22, v22, v23
    v_add_f32 v25, v20, v22
    buffer_store_dwordx2 v[24:25], v13, s[16:19], s69 offen offset:0 sc1
L_2:
    s_add_u32 s61, s60, 196608
    s_waitcnt vmcnt(7)
    buffer_load_dwordx4 a[192:195], v9, s[8:11], s61 offen offset:0 nt
    s_waitcnt vmcnt(7)
    buffer_load_dwordx4 a[196:199], v9, s[8:11], s61 offen offset:128 nt
    s_waitcnt vmcnt(7)
    buffer_load_dwordx4 a[200:203], v9, s[8:11], s61 offen offset:2048 nt
    s_waitcnt vmcnt(7)
    buffer_load_dwordx4 a[204:207], v9, s[8:11], s61 offen offset:2176 nt
    s_add_u32 s61, s60, 212992
    s_waitcnt vmcnt(7)
    buffer_load_dwordx4 a[208:211], v9, s[8:11], s61 offen offset:0 nt
    s_waitcnt vmcnt(7)
    buffer_load_dwordx4 a[212:215], v9, s[8:11], s61 offen offset:128 nt
    s_waitcnt vmcnt(7)
    buffer_load_dwordx4 a[216:219], v9, s[8:11], s61 offen offset:2048 nt
    s_waitcnt vmcnt(7)
    buffer_load_dwordx4 a[220:223], v9, s[8:11], s61 offen offset:2176 nt
    s_add_u32 s61, s60, 229376
    s_waitcnt vmcnt(7)
    buffer_load_dwordx4 a[224:227], v9, s[8:11], s61 offen offset:0 nt
    s_waitcnt vmcnt(7)
    buffer_load_dwordx4 a[228:231], v9, s[8:11], s61 offen offset:128 nt
    s_waitcnt vmcnt(7)
    buffer_load_dwordx4 a[232:235], v9, s[8:11], s61 offen offset:2048 nt
    s_waitcnt vmcnt(7)
    buffer_load_dwordx4 a[236:239], v9, s[8:11], s61 offen offset:2176 nt
    s_add_u32 s61, s60, 245760
    s_waitcnt vmcnt(7)
    buffer_load_dwordx4 a[240:243], v9, s[8:11], s61 offen offset:0 nt
    s_waitcnt vmcnt(7)
    buffer_load_dwordx4 a[244:247], v9, s[8:11], s61 offen offset:128 nt
    s_waitcnt vmcnt(7)
    buffer_load_dwordx4 a[248:251], v9, s[8:11], s61 offen offset:2048 nt
    s_waitcnt vmcnt(7)
    buffer_load_dwordx4 a[252:255], v9, s[8:11], s61 offen offset:2176 nt
    s_add_u32 s61, s60, 262144
    s_waitcnt vmcnt(7)
    buffer_load_dwordx4 v[112:115], v9, s[8:11], s61 offen offset:0 nt
    s_waitcnt vmcnt(7)
    buffer_load_dwordx4 v[116:119], v9, s[8:11], s61 offen offset:128 nt
    s_waitcnt vmcnt(7)
    buffer_load_dwordx4 v[120:123], v9, s[8:11], s61 offen offset:2048 nt
    s_waitcnt vmcnt(7)
    buffer_load_dwordx4 v[124:127], v9, s[8:11], s61 offen offset:2176 nt
    s_add_u32 s61, s60, 278528
    s_waitcnt vmcnt(7)
    buffer_load_dwordx4 v[128:131], v9, s[8:11], s61 offen offset:0 nt
    s_waitcnt vmcnt(7)
    buffer_load_dwordx4 v[132:135], v9, s[8:11], s61 offen offset:128 nt
    s_waitcnt vmcnt(7)
    buffer_load_dwordx4 v[136:139], v9, s[8:11], s61 offen offset:2048 nt
    s_waitcnt vmcnt(7)
    buffer_load_dwordx4 v[140:143], v9, s[8:11], s61 offen offset:2176 nt
    s_add_u32 s61, s60, 294912
    s_waitcnt vmcnt(7)
    buffer_load_dwordx4 v[144:147], v9, s[8:11], s61 offen offset:0 nt
    s_waitcnt vmcnt(7)
    buffer_load_dwordx4 v[148:151], v9, s[8:11], s61 offen offset:128 nt
    s_waitcnt vmcnt(7)
    buffer_load_dwordx4 v[152:155], v9, s[8:11], s61 offen offset:2048 nt
    s_waitcnt vmcnt(7)
    buffer_load_dwordx4 v[156:159], v9, s[8:11], s61 offen offset:2176 nt
    s_add_u32 s61, s60, 311296
    s_waitcnt vmcnt(7)
    buffer_load_dwordx4 v[160:163], v9, s[8:11], s61 offen offset:0 nt
    s_waitcnt vmcnt(7)
    buffer_load_dwordx4 v[164:167], v9, s[8:11], s61 offen offset:128 nt
    s_waitcnt vmcnt(7)
    buffer_load_dwordx4 v[168:171], v9, s[8:11], s61 offen offset:2048 nt
    s_waitcnt vmcnt(7)
    buffer_load_dwordx4 v[172:175], v9, s[8:11], s61 offen offset:2176 nt
    buffer_load_dword v52, off, s[48:51], 0 sc1
    s_add_u32 s61, s60, 327680
    s_waitcnt vmcnt(7)
    buffer_load_dwordx4 v[176:179], v9, s[8:11], s61 offen offset:0 nt
    s_waitcnt vmcnt(7)
    buffer_load_dwordx4 v[180:183], v9, s[8:11], s61 offen offset:128 nt
    s_waitcnt vmcnt(7)
    buffer_load_dwordx4 v[184:187], v9, s[8:11], s61 offen offset:2048 nt
    s_waitcnt vmcnt(7)
    buffer_load_dwordx4 v[188:191], v9, s[8:11], s61 offen offset:2176 nt
    s_add_u32 s61, s60, 344064
    s_waitcnt vmcnt(7)
    buffer_load_dwordx4 v[192:195], v9, s[8:11], s61 offen offset:0 nt
    s_waitcnt vmcnt(7)
    buffer_load_dwordx4 v[196:199], v9, s[8:11], s61 offen offset:128 nt
    s_waitcnt vmcnt(7)
    buffer_load_dwordx4 v[200:203], v9, s[8:11], s61 offen offset:2048 nt
    s_waitcnt vmcnt(7)
    buffer_load_dwordx4 v[204:207], v9, s[8:11], s61 offen offset:2176 nt
    s_add_u32 s61, s60, 360448
    s_waitcnt vmcnt(7)
    buffer_load_dwordx4 v[208:211], v9, s[8:11], s61 offen offset:0 nt
    s_waitcnt vmcnt(7)
    buffer_load_dwordx4 v[212:215], v9, s[8:11], s61 offen offset:128 nt
    s_waitcnt vmcnt(7)
    buffer_load_dwordx4 v[216:219], v9, s[8:11], s61 offen offset:2048 nt
    s_waitcnt vmcnt(7)
    buffer_load_dwordx4 v[220:223], v9, s[8:11], s61 offen offset:2176 nt
    s_add_u32 s61, s60, 376832
    s_waitcnt vmcnt(7)
    buffer_load_dwordx4 v[224:227], v9, s[8:11], s61 offen offset:0 nt
    s_waitcnt vmcnt(7)
    buffer_load_dwordx4 v[228:231], v9, s[8:11], s61 offen offset:128 nt
    s_waitcnt vmcnt(7)
    buffer_load_dwordx4 v[232:235], v9, s[8:11], s61 offen offset:2048 nt
    s_waitcnt vmcnt(7)
    buffer_load_dwordx4 v[236:239], v9, s[8:11], s61 offen offset:2176 nt
    s_add_u32 s61, s60, 393216
    s_waitcnt vmcnt(7)
    buffer_load_dwordx4 v[240:243], v9, s[8:11], s61 offen offset:0 nt
    s_waitcnt vmcnt(7)
    buffer_load_dwordx4 v[244:247], v9, s[8:11], s61 offen offset:128 nt
    s_waitcnt vmcnt(7)
    buffer_load_dwordx4 v[248:251], v9, s[8:11], s61 offen offset:2048 nt
    s_waitcnt vmcnt(7)
    buffer_load_dwordx4 v[252:255], v9, s[8:11], s61 offen offset:2176 nt
    s_mul_i32 s84, s3, 36864
    s_add_u32 s84, s84, 12288
    s_waitcnt vmcnt(20)
    v_cmp_gt_u32 vcc, 256, v52
    s_cbranch_vccz CNTD_4
CNT_3:
    buffer_load_dword v52, off, s[48:51], 0 sc1
    s_waitcnt vmcnt(0)
    v_cmp_gt_u32 vcc, 256, v52
    s_cbranch_vccz CNTD_4
    s_cmp_eq_u32 s65, 0
    s_cbranch_scc1 CNTD_4
    s_sub_u32 s65, s65, 1
    s_branch CNT_3
CNTD_4:
    v_and_b32 v13, 31, v1
    v_lshlrev_b32 v13, 13, v13
    buffer_load_dword v12, v13, s[16:19], s71 offen offset:3968 sc1
    s_cmp_ge_u32 s3, 2
    s_cbranch_scc1 L_5
    v_lshrrev_b32 v14, 3, v1
    v_lshlrev_b32 v14, 18, v14
    v_and_b32 v15, 7, v1
    v_lshl_add_u32 v14, v15, 5, v14
    s_add_u32 s68, s70, s62
    buffer_load_dwordx4 v[32:35], v14, s[16:19], s68 offen offset:1024 sc1
    buffer_load_dwordx4 v[36:39], v14, s[16:19], s68 offen offset:1040 sc1
    v_lshlrev_b32 v13, 3, v0
    s_add_u32 s69, s68, 0
    buffer_load_dwordx2 v[16:17], v13, s[16:19], s69 offen offset:0 sc1
    s_add_u32 s69, s68, 262144
    buffer_load_dwordx2 v[18:19], v13, s[16:19], s69 offen offset:0 sc1
    s_add_u32 s69, s68, 524288
    buffer_load_dwordx2 v[20:21], v13, s[16:19], s69 offen offset:0 sc1
    s_add_u32 s69, s68, 786432
    buffer_load_dwordx2 v[22:23], v13, s[16:19], s69 offen offset:0 sc1
    s_add_u32 s69, s68, 1048576
    buffer_load_dwordx2 v[24:25], v13, s[16:19], s69 offen offset:0 sc1
    s_add_u32 s69, s68, 1310720
    buffer_load_dwordx2 v[26:27], v13, s[16:19], s69 offen offset:0 sc1
    s_add_u32 s69, s68, 1572864
    buffer_load_dwordx2 v[28:29], v13, s[16:19], s69 offen offset:0 sc1
    s_add_u32 s69, s68, 1835008
    buffer_load_dwordx2 v[30:31], v13, s[16:19], s69 offen offset:0 sc1
L_5:
    s_waitcnt vmcnt(7)
    s_add_u32 s61, s60, 0
    s_add_u32 m0, s84, 0
    s_nop 0
    buffer_load_dwordx4 v2, s[12:15], s61 offen nt lds
    s_waitcnt vmcnt(7)
    s_add_u32 s61, s60, 256
    s_add_u32 m0, s84, 1024
    s_nop 0
    buffer_load_dwordx4 v2, s[12:15], s61 offen nt lds
    s_waitcnt vmcnt(7)
    s_add_u32 s61, s60, 2048
    s_add_u32 m0, s84, 2048
    s_nop 0
    buffer_load_dwordx4 v2, s[12:15], s61 offen nt lds
    s_waitcnt vmcnt(7)
    s_add_u32 s61, s60, 2304
    s_add_u32 m0, s84, 3072
    s_nop 0
    buffer_load_dwordx4 v2, s[12:15], s61 offen nt lds
    s_waitcnt vmcnt(7)
    s_add_u32 s61, s60, 16384
    s_add_u32 m0, s84, 4096
    s_nop 0
    buffer_load_dwordx4 v2, s[12:15], s61 offen nt lds
    s_waitcnt vmcnt(7)
    s_add_u32 s61, s60, 16640
    s_add_u32 m0, s84, 5120
    s_nop 0
    buffer_load_dwordx4 v2, s[12:15], s61 offen nt lds
    s_waitcnt vmcnt(7)
    s_add_u32 s61, s60, 18432
    s_add_u32 m0, s84, 6144
    s_nop 0
    buffer_load_dwordx4 v2, s[12:15], s61 offen nt lds
    s_waitcnt vmcnt(7)
    s_add_u32 s61, s60, 18688
    s_add_u32 m0, s84, 7168
    s_nop 0
    buffer_load_dwordx4 v2, s[12:15], s61 offen nt lds
    s_waitcnt vmcnt(7)
    s_add_u32 s61, s60, 32768
    s_add_u32 m0, s84, 8192
    s_nop 0
    buffer_load_dwordx4 v2, s[12:15], s61 offen nt lds
    s_waitcnt vmcnt(7)
    s_add_u32 s61, s60, 33024
    s_add_u32 m0, s84, 9216
    s_nop 0
    buffer_load_dwordx4 v2, s[12:15], s61 offen nt lds
    s_waitcnt vmcnt(7)
    s_add_u32 s61, s60, 34816
    s_add_u32 m0, s84, 10240
    s_nop 0
    buffer_load_dwordx4 v2, s[12:15], s61 offen nt lds
    s_waitcnt vmcnt(7)
    s_add_u32 s61, s60, 35072
    s_add_u32 m0, s84, 11264
    s_nop 0
    buffer_load_dwordx4 v2, s[12:15], s61 offen nt lds
    s_waitcnt vmcnt(7)
    s_add_u32 s61, s60, 49152
    s_add_u32 m0, s84, 12288
    s_nop 0
    buffer_load_dwordx4 v2, s[12:15], s61 offen nt lds
    s_waitcnt vmcnt(7)
    s_add_u32 s61, s60, 49408
    s_add_u32 m0, s84, 13312
    s_nop 0
    buffer_load_dwordx4 v2, s[12:15], s61 offen nt lds
    s_waitcnt vmcnt(7)
    s_add_u32 s61, s60, 51200
    s_add_u32 m0, s84, 14336
    s_nop 0
    buffer_load_dwordx4 v2, s[12:15], s61 offen nt lds
    s_waitcnt vmcnt(7)
    s_add_u32 s61, s60, 51456
    s_add_u32 m0, s84, 15360
    s_nop 0
    buffer_load_dwordx4 v2, s[12:15], s61 offen nt lds
    s_waitcnt vmcnt(7)
    s_add_u32 s61, s60, 65536
    s_add_u32 m0, s84, 16384
    s_nop 0
    buffer_load_dwordx4 v2, s[12:15], s61 offen nt lds
    s_waitcnt vmcnt(7)
    s_add_u32 s61, s60, 65792
    s_add_u32 m0, s84, 17408
    s_nop 0
    buffer_load_dwordx4 v2, s[12:15], s61 offen nt lds
    s_waitcnt vmcnt(7)
    s_add_u32 s61, s60, 67584
    s_add_u32 m0, s84, 18432
    s_nop 0
    buffer_load_dwordx4 v2, s[12:15], s61 offen nt lds
    s_waitcnt vmcnt(7)
    s_add_u32 s61, s60, 67840
    s_add_u32 m0, s84, 19456
    s_nop 0
    buffer_load_dwordx4 v2, s[12:15], s61 offen nt lds
    s_cmp_ge_u32 s3, 2
    s_cbranch_scc1 L_6
    s_waitcnt vmcnt(20)
    v_max_u32 v15, v16, v17
    v_max3_u32 v15, v15, v18, v19
    v_max3_u32 v15, v15, v20, v21
    v_max3_u32 v15, v15, v22, v23
    v_max3_u32 v15, v15, v24, v25
    v_max3_u32 v15, v15, v26, v27
    v_max3_u32 v15, v15, v28, v29
    v_max3_u32 v15, v15, v30, v31
    v_max3_u32 v15, v15, v32, v33
    v_max3_u32 v15, v15, v34, v35
    v_max3_u32 v15, v15, v36, v37
    v_max3_u32 v15, v15, v38, v39
    v_cmp_eq_u32 vcc, -1, v15
    s_cbranch_vccz PDONE_8
POLL_7:
    v_lshrrev_b32 v14, 3, v1
    v_lshlrev_b32 v14, 18, v14
    v_and_b32 v15, 7, v1
    v_lshl_add_u32 v14, v15, 5, v14
    s_add_u32 s68, s70, s62
    buffer_load_dwordx4 v[32:35], v14, s[16:19], s68 offen offset:1024 sc1
    buffer_load_dwordx4 v[36:39], v14, s[16:19], s68 offen offset:1040 sc1
    v_lshlrev_b32 v13, 3, v0
    s_add_u32 s69, s68, 0
    buffer_load_dwordx2 v[16:17], v13, s[16:19], s69 offen offset:0 sc1
    s_add_u32 s69, s68, 262144
    buffer_load_dwordx2 v[18:19], v13, s[16:19], s69 offen offset:0 sc1
    s_add_u32 s69, s68, 524288
    buffer_load_dwordx2 v[20:21], v13, s[16:19], s69 offen offset:0 sc1
    s_add_u32 s69, s68, 786432
    buffer_load_dwordx2 v[22:23], v13, s[16:19], s69 offen offset:0 sc1
    s_add_u32 s69, s68, 1048576
    buffer_load_dwordx2 v[24:25], v13, s[16:19], s69 offen offset:0 sc1
    s_add_u32 s69, s68, 1310720
    buffer_load_dwordx2 v[26:27], v13, s[16:19], s69 offen offset:0 sc1
    s_add_u32 s69, s68, 1572864
    buffer_load_dwordx2 v[28:29], v13, s[16:19], s69 offen offset:0 sc1
    s_add_u32 s69, s68, 1835008
    buffer_load_dwordx2 v[30:31], v13, s[16:19], s69 offen offset:0 sc1
    s_waitcnt vmcnt(0)
    v_max_u32 v15, v16, v17
    v_max3_u32 v15, v15, v18, v19
    v_max3_u32 v15, v15, v20, v21
    v_max3_u32 v15, v15, v22, v23
    v_max3_u32 v15, v15, v24, v25
    v_max3_u32 v15, v15, v26, v27
    v_max3_u32 v15, v15, v28, v29
    v_max3_u32 v15, v15, v30, v31
    v_max3_u32 v15, v15, v32, v33
    v_max3_u32 v15, v15, v34, v35
    v_max3_u32 v15, v15, v36, v37
    v_max3_u32 v15, v15, v38, v39
    v_cmp_eq_u32 vcc, -1, v15
    s_cbranch_vccz PDONE_8
    s_cmp_eq_u32 s65, 0
    s_cbranch_scc1 PDONE_8
    s_sub_u32 s65, s65, 1
    s_branch POLL_7
PDONE_8:
    v_lshlrev_b32 v41, 2, v0
    v_add_f32 v13, v32, v33
    v_add_f32 v13, v13, v34
    v_add_f32 v13, v13, v35
    v_add_f32 v13, v13, v36
    v_add_f32 v13, v13, v37
    v_add_f32 v13, v13, v38
    v_add_f32 v13, v13, v39
    s_nop 1
    v_add_f32_dpp v13, v13, v13 quad_perm:[1,0,3,2] row_mask:0xf bank_mask:0xf
    s_nop 1
    v_add_f32_dpp v13, v13, v13 quad_perm:[2,3,0,1] row_mask:0xf bank_mask:0xf
    s_nop 1
    v_add_f32_dpp v13, v13, v13 row_half_mirror row_mask:0xf bank_mask:0xf
    s_nop 1
    v_add_f32_dpp v13, v13, v13 row_mirror row_mask:0xf bank_mask:0xf
    v_mov_b32 v15, v13
    s_nop 1
    v_permlane16_swap_b32 v15, v13
    v_add_f32 v13, v15, v13
    v_mov_b32 v15, v13
    s_nop 1
    v_permlane32_swap_b32 v15, v13
    v_add_f32 v13, v15, v13
    v_mul_f32 v13, 0x3b000000, v13
    v_sub_f32 v32, v32, v13
    v_sub_f32 v33, v33, v13
    v_sub_f32 v34, v34, v13
    v_sub_f32 v35, v35, v13
    v_sub_f32 v36, v36, v13
    v_sub_f32 v37, v37, v13
    v_sub_f32 v38, v38, v13
    v_sub_f32 v39, v39, v13
    v_mul_f32 v14, v32, v32
    v_fmac_f32 v14, v33, v33
    v_fmac_f32 v14, v34, v34
    v_fmac_f32 v14, v35, v35
    v_fmac_f32 v14, v36, v36
    v_fmac_f32 v14, v37, v37
    v_fmac_f32 v14, v38, v38
    v_fmac_f32 v14, v39, v39
    s_nop 1
    v_add_f32_dpp v14, v14, v14 quad_perm:[1,0,3,2] row_mask:0xf bank_mask:0xf
    s_nop 1
    v_add_f32_dpp v14, v14, v14 quad_perm:[2,3,0,1] row_mask:0xf bank_mask:0xf
    s_nop 1
    v_add_f32_dpp v14, v14, v14 row_half_mirror row_mask:0xf bank_mask:0xf
    s_nop 1
    v_add_f32_dpp v14, v14, v14 row_mirror row_mask:0xf bank_mask:0xf
    v_mov_b32 v15, v14
    s_nop 1
    v_permlane16_swap_b32 v15, v14
    v_add_f32 v14, v15, v14
    v_mov_b32 v15, v14
    s_nop 1
    v_permlane32_swap_b32 v15, v14
    v_add_f32 v14, v15, v14
    v_mov_b32 v15, 0x3727c5ac
    v_fmac_f32 v15, 0x3b000000, v14
    v_rsq_f32 v14, v15
    s_nop 0
    v_add_f32 v16, v16, v18
    v_add_f32 v17, v17, v19
    v_add_f32 v16, v16, v20
    v_add_f32 v17, v17, v21
    v_add_f32 v16, v16, v22
    v_add_f32 v17, v17, v23
    v_add_f32 v16, v16, v24
    v_add_f32 v17, v17, v25
    v_add_f32 v16, v16, v26
    v_add_f32 v17, v17, v27
    v_add_f32 v16, v16, v28
    v_add_f32 v17, v17, v29
    v_add_f32 v16, v16, v30
    v_add_f32 v17, v17, v31
    ds_write_b32 v41, v17 offset:9216
    v_fma_f32 v16, -v13, v17, v16
    v_mul_f32 v16, v16, v14
    v_cvt_pk_bf16_f32 v16, v16, v16
    v_lshlrev_b32 v13, 1, v0
    ds_write_b16 v13, v16 offset:8960
L_6:
    s_waitcnt vmcnt(7)
    s_add_u32 s61, s60, 81920
    s_add_u32 m0, s84, 20480
    s_nop 0
    buffer_load_dwordx4 v2, s[12:15], s61 offen nt lds
    s_waitcnt vmcnt(7)
    s_add_u32 s61, s60, 82176
    s_add_u32 m0, s84, 21504
    s_nop 0
    buffer_load_dwordx4 v2, s[12:15], s61 offen nt lds
    s_waitcnt vmcnt(7)
    s_add_u32 s61, s60, 83968
    s_add_u32 m0, s84, 22528
    s_nop 0
    buffer_load_dwordx4 v2, s[12:15], s61 offen nt lds
    s_waitcnt vmcnt(7)
    s_add_u32 s61, s60, 84224
    s_add_u32 m0, s84, 23552
    s_nop 0
    buffer_load_dwordx4 v2, s[12:15], s61 offen nt lds
    s_waitcnt vmcnt(7)
    s_add_u32 s61, s60, 98304
    s_add_u32 m0, s84, 24576
    s_nop 0
    buffer_load_dwordx4 v2, s[12:15], s61 offen nt lds
    s_waitcnt vmcnt(7)
    s_add_u32 s61, s60, 98560
    s_add_u32 m0, s84, 25600
    s_nop 0
    buffer_load_dwordx4 v2, s[12:15], s61 offen nt lds
    s_waitcnt vmcnt(7)
    s_add_u32 s61, s60, 100352
    s_add_u32 m0, s84, 26624
    s_nop 0
    buffer_load_dwordx4 v2, s[12:15], s61 offen nt lds
    s_waitcnt vmcnt(7)
    s_add_u32 s61, s60, 100608
    s_add_u32 m0, s84, 27648
    s_nop 0
    buffer_load_dwordx4 v2, s[12:15], s61 offen nt lds
    s_waitcnt lgkmcnt(0)
    s_barrier
    v_lshrrev_b32 v13, 4, v1
    v_lshlrev_b32 v13, 5, v13
    v_and_b32 v14, 1, v1
    v_lshl_add_u32 v13, v14, 4, v13
    ds_read_b128 v[40:43], v13 offset:8960
    ds_read_b128 v[44:47], v13 offset:9088
    v_bfe_u32 v13, v1, 1, 2
    v_lshl_add_u32 v13, v13, 2, v8
    s_waitcnt lgkmcnt(0)
    s_waitcnt vmcnt(63)
    v_mfma_f32_16x16x32_bf16 v[48:51], a[0:3], v[40:43], 0
    s_nop 1
    v_mfma_f32_16x16x32_bf16 v[48:51], a[4:7], v[44:47], v[48:51]
    v_mfma_f32_16x16x32_bf16 v[52:55], a[8:11], v[40:43], 0
    v_mfma_f32_16x16x32_bf16 v[52:55], a[12:15], v[44:47], v[52:55]
    s_waitcnt vmcnt(7)
    s_add_u32 s61, s60, 114688
    s_add_u32 m0, s84, 28672
    s_nop 0
    buffer_load_dwordx4 v2, s[12:15], s61 offen nt lds
    s_waitcnt vmcnt(63)
    s_nop 7
    s_nop 3
    v_mfma_f32_16x16x32_bf16 v[56:59], a[16:19], v[40:43], 0
    v_cndmask_b32_e64 v16, v49, v48, s[52:53]
    v_cndmask_b32_e64 v17, v51, v50, s[52:53]
    v_mfma_f32_16x16x32_bf16 v[56:59], a[20:23], v[44:47], v[56:59]
    v_cndmask_b32_e64 v18, v17, v16, s[90:91]
    v_mfma_f32_16x16x32_bf16 v[60:63], a[24:27], v[40:43], 0
    v_cndmask_b32_e64 v16, v53, v52, s[52:53]
    v_cndmask_b32_e64 v17, v55, v54, s[52:53]
    v_mfma_f32_16x16x32_bf16 v[60:63], a[28:31], v[44:47], v[60:63]
    v_cndmask_b32_e64 v16, v17, v16, s[90:91]
    v_cndmask_b32_e64 v20, v16, v18, s[92:93]
    s_waitcnt vmcnt(7)
    s_add_u32 s61, s60, 114944
    s_add_u32 m0, s84, 29696
    s_nop 0
    buffer_load_dwordx4 v2, s[12:15], s61 offen nt lds
    s_waitcnt vmcnt(63)
    v_mfma_f32_16x16x32_bf16 v[48:51], a[32:35], v[40:43], 0
    v_cndmask_b32_e64 v16, v57, v56, s[52:53]
    v_cndmask_b32_e64 v17, v59, v58, s[52:53]
    v_add_f32_dpp v22, v20, v20 quad_perm:[1,0,3,2] row_mask:0xf bank_mask:0xf
    s_mov_b64 exec, s[94:95]
    ds_write_b32 v13, v22 offset:0
    s_mov_b64 exec, -1
    v_mfma_f32_16x16x32_bf16 v[48:51], a[36:39], v[44:47], v[48:51]
    v_cndmask_b32_e64 v18, v17, v16, s[90:91]
    v_mfma_f32_16x16x32_bf16 v[52:55], a[40:43], v[40:43], 0
    v_cndmask_b32_e64 v16, v61, v60, s[52:53]
    v_cndmask_b32_e64 v17, v63, v62, s[52:53]
    v_mfma_f32_16x16x32_bf16 v[52:55], a[44:47], v[44:47], v[52:55]
    v_cndmask_b32_e64 v16, v17, v16, s[90:91]
    v_cndmask_b32_e64 v21, v16, v18, s[92:93]
    s_waitcnt vmcnt(7)
    s_add_u32 s61, s60, 116736
    s_add_u32 m0, s84, 30720
    s_nop 0
    buffer_load_dwordx4 v2, s[12:15], s61 offen nt lds
    s_waitcnt vmcnt(63)
    v_mfma_f32_16x16x32_bf16 v[56:59], a[48:51], v[40:43], 0
    v_cndmask_b32_e64 v16, v49, v48, s[52:53]
    v_cndmask_b32_e64 v17, v51, v50, s[52:53]
    v_add_f32_dpp v23, v21, v21 quad_perm:[1,0,3,2] row_mask:0xf bank_mask:0xf
    s_mov_b64 exec, s[94:95]
    ds_write_b32 v13, v23 offset:64
    s_mov_b64 exec, -1
    v_mfma_f32_16x16x32_bf16 v[56:59], a[52:55], v[44:47], v[56:59]
    v_cndmask_b32_e64 v18, v17, v16, s[90:91]
    v_mfma_f32_16x16x32_bf16 v[60:63], a[56:59], v[40:43], 0
    v_cndmask_b32_e64 v16, v53, v52, s[52:53]
    v_cndmask_b32_e64 v17, v55, v54, s[52:53]
    v_mfma_f32_16x16x32_bf16 v[60:63], a[60:63], v[44:47], v[60:63]
    v_cndmask_b32_e64 v16, v17, v16, s[90:91]
    v_cndmask_b32_e64 v20, v16, v18, s[92:93]
    s_waitcnt vmcnt(7)
    s_add_u32 s61, s60, 116992
    s_add_u32 m0, s84, 31744
    s_nop 0
    buffer_load_dwordx4 v2, s[12:15], s61 offen nt lds
    s_waitcnt vmcnt(63)
    v_mfma_f32_16x16x32_bf16 v[48:51], a[64:67], v[40:43], 0
    v_cndmask_b32_e64 v16, v57, v56, s[52:53]
    v_cndmask_b32_e64 v17, v59, v58, s[52:53]
    v_add_f32_dpp v22, v20, v20 quad_perm:[1,0,3,2] row_mask:0xf bank_mask:0xf
    s_mov_b64 exec, s[94:95]
    ds_write_b32 v13, v22 offset:128
    s_mov_b64 exec, -1
    v_mfma_f32_16x16x32_bf16 v[48:51], a[68:71], v[44:47], v[48:51]
    v_cndmask_b32_e64 v18, v17, v16, s[90:91]
    v_mfma_f32_16x16x32_bf16 v[52:55], a[72:75], v[40:43], 0
    v_cndmask_b32_e64 v16, v61, v60, s[52:53]
    v_cndmask_b32_e64 v17, v63, v62, s[52:53]
    v_mfma_f32_16x16x32_bf16 v[52:55], a[76:79], v[44:47], v[52:55]
    v_cndmask_b32_e64 v16, v17, v16, s[90:91]
    v_cndmask_b32_e64 v21, v16, v18, s[92:93]
    s_waitcnt vmcnt(7)
    s_add_u32 s61, s60, 131072
    s_add_u32 m0, s84, 32768
    s_nop 0
    buffer_load_dwordx4 v2, s[12:15], s61 offen nt lds
    s_waitcnt vmcnt(63)
    v_mfma_f32_16x16x32_bf16 v[56:59], a[80:83], v[40:43], 0
    v_cndmask_b32_e64 v16, v49, v48, s[52:53]
    v_cndmask_b32_e64 v17, v51, v50, s[52:53]
    v_add_f32_dpp v23, v21, v21 quad_perm:[1,0,3,2] row_mask:0xf bank_mask:0xf
    s_mov_b64 exec, s[94:95]
    ds_write_b32 v13, v23 offset:192
    s_mov_b64 exec, -1
    v_mfma_f32_16x16x32_bf16 v[56:59], a[84:87], v[44:47], v[56:59]
    v_cndmask_b32_e64 v18, v17, v16, s[90:91]
    v_mfma_f32_16x16x32_bf16 v[60:63], a[88:91], v[40:43], 0
    v_cndmask_b32_e64 v16, v53, v52, s[52:53]
    v_cndmask_b32_e64 v17, v55, v54, s[52:53]
    v_mfma_f32_16x16x32_bf16 v[60:63], a[92:95], v[44:47], v[60:63]
    v_cndmask_b32_e64 v16, v17, v16, s[90:91]
    v_cndmask_b32_e64 v20, v16, v18, s[92:93]
    s_waitcnt vmcnt(7)
    s_add_u32 s61, s60, 131328
    s_add_u32 m0, s84, 33792
    s_nop 0
    buffer_load_dwordx4 v2, s[12:15], s61 offen nt lds
    s_waitcnt vmcnt(63)
    v_mfma_f32_16x16x32_bf16 v[48:51], a[96:99], v[40:43], 0
    v_cndmask_b32_e64 v16, v57, v56, s[52:53]
    v_cndmask_b32_e64 v17, v59, v58, s[52:53]
    v_add_f32_dpp v22, v20, v20 quad_perm:[1,0,3,2] row_mask:0xf bank_mask:0xf
    s_mov_b64 exec, s[94:95]
    ds_write_b32 v13, v22 offset:256
    s_mov_b64 exec, -1
    v_mfma_f32_16x16x32_bf16 v[48:51], a[100:103], v[44:47], v[48:51]
    v_cndmask_b32_e64 v18, v17, v16, s[90:91]
    v_mfma_f32_16x16x32_bf16 v[52:55], a[104:107], v[40:43], 0
    v_cndmask_b32_e64 v16, v61, v60, s[52:53]
    v_cndmask_b32_e64 v17, v63, v62, s[52:53]
    v_mfma_f32_16x16x32_bf16 v[52:55], a[108:111], v[44:47], v[52:55]
    v_cndmask_b32_e64 v16, v17, v16, s[90:91]
    v_cndmask_b32_e64 v21, v16, v18, s[92:93]
    s_waitcnt vmcnt(7)
    s_add_u32 s61, s60, 133120
    s_add_u32 m0, s84, 34816
    s_nop 0
    buffer_load_dwordx4 v2, s[12:15], s61 offen nt lds
    s_waitcnt vmcnt(63)
    v_mfma_f32_16x16x32_bf16 v[56:59], a[112:115], v[40:43], 0
    v_cndmask_b32_e64 v16, v49, v48, s[52:53]
    v_cndmask_b32_e64 v17, v51, v50, s[52:53]
    v_add_f32_dpp v23, v21, v21 quad_perm:[1,0,3,2] row_mask:0xf bank_mask:0xf
    s_mov_b64 exec, s[94:95]
    ds_write_b32 v13, v23 offset:320
    s_mov_b64 exec, -1
    v_mfma_f32_16x16x32_bf16 v[56:59], a[116:119], v[44:47], v[56:59]
    v_cndmask_b32_e64 v18, v17, v16, s[90:91]
    v_mfma_f32_16x16x32_bf16 v[60:63], a[120:123], v[40:43], 0
    v_cndmask_b32_e64 v16, v53, v52, s[52:53]
    v_cndmask_b32_e64 v17, v55, v54, s[52:53]
    v_mfma_f32_16x16x32_bf16 v[60:63], a[124:127], v[44:47], v[60:63]
    v_cndmask_b32_e64 v16, v17, v16, s[90:91]
    v_cndmask_b32_e64 v20, v16, v18, s[92:93]
    s_waitcnt vmcnt(7)
    s_add_u32 s61, s60, 133376
    s_add_u32 m0, s84, 35840
    s_nop 0
    buffer_load_dwordx4 v2, s[12:15], s61 offen nt lds
    s_waitcnt vmcnt(63)
    v_mfma_f32_16x16x32_bf16 v[48:51], a[128:131], v[40:43], 0
    v_cndmask_b32_e64 v16, v57, v56, s[52:53]
    v_cndmask_b32_e64 v17, v59, v58, s[52:53]
    v_add_f32_dpp v22, v20, v20 quad_perm:[1,0,3,2] row_mask:0xf bank_mask:0xf
    s_mov_b64 exec, s[94:95]
    ds_write_b32 v13, v22 offset:384
    s_mov_b64 exec, -1
    v_mfma_f32_16x16x32_bf16 v[48:51], a[132:135], v[44:47], v[48:51]
    v_cndmask_b32_e64 v18, v17, v16, s[90:91]
    v_mfma_f32_16x16x32_bf16 v[52:55], a[136:139], v[40:43], 0
    v_cndmask_b32_e64 v16, v61, v60, s[52:53]
    v_cndmask_b32_e64 v17, v63, v62, s[52:53]
    v_mfma_f32_16x16x32_bf16 v[52:55], a[140:143], v[44:47], v[52:55]
    v_cndmask_b32_e64 v16, v17, v16, s[90:91]
    v_cndmask_b32_e64 v21, v16, v18, s[92:93]
    s_add_u32 s61, s60, 147456
    buffer_load_dwordx4 v[64:67], v2, s[12:15], s61 offen offset:0 nt
    s_waitcnt vmcnt(63)
    v_mfma_f32_16x16x32_bf16 v[56:59], a[144:147], v[40:43], 0
    v_cndmask_b32_e64 v16, v49, v48, s[52:53]
    v_cndmask_b32_e64 v17, v51, v50, s[52:53]
    v_add_f32_dpp v23, v21, v21 quad_perm:[1,0,3,2] row_mask:0xf bank_mask:0xf
    s_mov_b64 exec, s[94:95]
    ds_write_b32 v13, v23 offset:448
    s_mov_b64 exec, -1
    v_mfma_f32_16x16x32_bf16 v[56:59], a[148:151], v[44:47], v[56:59]
    v_cndmask_b32_e64 v18, v17, v16, s[90:91]
    v_mfma_f32_16x16x32_bf16 v[60:63], a[152:155], v[40:43], 0
    v_cndmask_b32_e64 v16, v53, v52, s[52:53]
    v_cndmask_b32_e64 v17, v55, v54, s[52:53]
    v_mfma_f32_16x16x32_bf16 v[60:63], a[156:159], v[44:47], v[60:63]
    v_cndmask_b32_e64 v16, v17, v16, s[90:91]
    v_cndmask_b32_e64 v20, v16, v18, s[92:93]
    s_add_u32 s61, s60, 147456
    buffer_load_dwordx4 v[68:71], v2, s[12:15], s61 offen offset:256 nt
    s_waitcnt vmcnt(63)
    v_mfma_f32_16x16x32_bf16 v[48:51], a[160:163], v[40:43], 0
    v_cndmask_b32_e64 v16, v57, v56, s[52:53]
    v_cndmask_b32_e64 v17, v59, v58, s[52:53]
    v_add_f32_dpp v22, v20, v20 quad_perm:[1,0,3,2] row_mask:0xf bank_mask:0xf
    s_mov_b64 exec, s[94:95]
    ds_write_b32 v13, v22 offset:512
    s_mov_b64 exec, -1
    v_mfma_f32_16x16x32_bf16 v[48:51], a[164:167], v[44:47], v[48:51]
    v_cndmask_b32_e64 v18, v17, v16, s[90:91]
    v_mfma_f32_16x16x32_bf16 v[52:55], a[168:171], v[40:43], 0
    v_cndmask_b32_e64 v16, v61, v60, s[52:53]
    v_cndmask_b32_e64 v17, v63, v62, s[52:53]
    v_mfma_f32_16x16x32_bf16 v[52:55], a[172:175], v[44:47], v[52:55]
    v_cndmask_b32_e64 v16, v17, v16, s[90:91]
    v_cndmask_b32_e64 v21, v16, v18, s[92:93]
    s_add_u32 s61, s60, 147456
    buffer_load_dwordx4 v[72:75], v2, s[12:15], s61 offen offset:2048 nt
    s_waitcnt vmcnt(63)
    v_mfma_f32_16x16x32_bf16 v[56:59], a[176:179], v[40:43], 0
    v_cndmask_b32_e64 v16, v49, v48, s[52:53]
    v_cndmask_b32_e64 v17, v51, v50, s[52:53]
    v_add_f32_dpp v23, v21, v21 quad_perm:[1,0,3,2] row_mask:0xf bank_mask:0xf
    s_mov_b64 exec, s[94:95]
    ds_write_b32 v13, v23 offset:576
    s_mov_b64 exec, -1
    v_mfma_f32_16x16x32_bf16 v[56:59], a[180:183], v[44:47], v[56:59]
    v_cndmask_b32_e64 v18, v17, v16, s[90:91]
    v_mfma_f32_16x16x32_bf16 v[60:63], a[184:187], v[40:43], 0
    v_cndmask_b32_e64 v16, v53, v52, s[52:53]
    v_cndmask_b32_e64 v17, v55, v54, s[52:53]
    v_mfma_f32_16x16x32_bf16 v[60:63], a[188:191], v[44:47], v[60:63]
    v_cndmask_b32_e64 v16, v17, v16, s[90:91]
    v_cndmask_b32_e64 v20, v16, v18, s[92:93]
    s_add_u32 s61, s60, 147456
    buffer_load_dwordx4 v[76:79], v2, s[12:15], s61 offen offset:2304 nt
    s_waitcnt vmcnt(63)
    v_mfma_f32_16x16x32_bf16 v[48:51], a[192:195], v[40:43], 0
    v_cndmask_b32_e64 v16, v57, v56, s[52:53]
    v_cndmask_b32_e64 v17, v59, v58, s[52:53]
    v_add_f32_dpp v22, v20, v20 quad_perm:[1,0,3,2] row_mask:0xf bank_mask:0xf
    s_mov_b64 exec, s[94:95]
    ds_write_b32 v13, v22 offset:640
    s_mov_b64 exec, -1
    v_mfma_f32_16x16x32_bf16 v[48:51], a[196:199], v[44:47], v[48:51]
    v_cndmask_b32_e64 v18, v17, v16, s[90:91]
    v_mfma_f32_16x16x32_bf16 v[52:55], a[200:203], v[40:43], 0
    v_cndmask_b32_e64 v16, v61, v60, s[52:53]
    v_cndmask_b32_e64 v17, v63, v62, s[52:53]
    v_mfma_f32_16x16x32_bf16 v[52:55], a[204:207], v[44:47], v[52:55]
    v_cndmask_b32_e64 v16, v17, v16, s[90:91]
    v_cndmask_b32_e64 v21, v16, v18, s[92:93]
    s_add_u32 s61, s60, 163840
    buffer_load_dwordx4 v[80:83], v2, s[12:15], s61 offen offset:0 nt
    s_waitcnt vmcnt(63)
    v_mfma_f32_16x16x32_bf16 v[56:59], a[208:211], v[40:43], 0
    v_cndmask_b32_e64 v16, v49, v48, s[52:53]
    v_cndmask_b32_e64 v17, v51, v50, s[52:53]
    v_add_f32_dpp v23, v21, v21 quad_perm:[1,0,3,2] row_mask:0xf bank_mask:0xf
    s_mov_b64 exec, s[94:95]
    ds_write_b32 v13, v23 offset:704
    s_mov_b64 exec, -1
    v_mfma_f32_16x16x32_bf16 v[56:59], a[212:215], v[44:47], v[56:59]
    v_cndmask_b32_e64 v18, v17, v16, s[90:91]
    v_mfma_f32_16x16x32_bf16 v[60:63], a[216:219], v[40:43], 0
    v_cndmask_b32_e64 v16, v53, v52, s[52:53]
    v_cndmask_b32_e64 v17, v55, v54, s[52:53]
    v_mfma_f32_16x16x32_bf16 v[60:63], a[220:223], v[44:47], v[60:63]
    v_cndmask_b32_e64 v16, v17, v16, s[90:91]
    v_cndmask_b32_e64 v20, v16, v18, s[92:93]
    s_add_u32 s61, s60, 163840
    buffer_load_dwordx4 v[84:87], v2, s[12:15], s61 offen offset:256 nt
    s_waitcnt vmcnt(63)
    v_mfma_f32_16x16x32_bf16 v[48:51], a[224:227], v[40:43], 0
    v_cndmask_b32_e64 v16, v57, v56, s[52:53]
    v_cndmask_b32_e64 v17, v59, v58, s[52:53]
    v_add_f32_dpp v22, v20, v20 quad_perm:[1,0,3,2] row_mask:0xf bank_mask:0xf
    s_mov_b64 exec, s[94:95]
    ds_write_b32 v13, v22 offset:768
    s_mov_b64 exec, -1
    v_mfma_f32_16x16x32_bf16 v[48:51], a[228:231], v[44:47], v[48:51]
    v_cndmask_b32_e64 v18, v17, v16, s[90:91]
    v_mfma_f32_16x16x32_bf16 v[52:55], a[232:235], v[40:43], 0
    v_cndmask_b32_e64 v16, v61, v60, s[52:53]
    v_cndmask_b32_e64 v17, v63, v62, s[52:53]
    v_mfma_f32_16x16x32_bf16 v[52:55], a[236:239], v[44:47], v[52:55]
    v_cndmask_b32_e64 v16, v17, v16, s[90:91]
    v_cndmask_b32_e64 v21, v16, v18, s[92:93]
    s_add_u32 s61, s60, 163840
    buffer_load_dwordx4 v[88:91], v2, s[12:15], s61 offen offset:2048 nt
    s_waitcnt vmcnt(63)
    v_mfma_f32_16x16x32_bf16 v[56:59], a[240:243], v[40:43], 0
    v_cndmask_b32_e64 v16, v49, v48, s[52:53]
    v_cndmask_b32_e64 v17, v51, v50, s[52:53]
    v_add_f32_dpp v23, v21, v21 quad_perm:[1,0,3,2] row_mask:0xf bank_mask:0xf
    s_mov_b64 exec, s[94:95]
    ds_write_b32 v13, v23 offset:832
    s_mov_b64 exec, -1
    v_mfma_f32_16x16x32_bf16 v[56:59], a[244:247], v[44:47], v[56:59]
    v_cndmask_b32_e64 v18, v17, v16, s[90:91]
    v_mfma_f32_16x16x32_bf16 v[60:63], a[248:251], v[40:43], 0
    v_cndmask_b32_e64 v16, v53, v52, s[52:53]
    v_cndmask_b32_e64 v17, v55, v54, s[52:53]
    v_mfma_f32_16x16x32_bf16 v[60:63], a[252:255], v[44:47], v[60:63]
    v_cndmask_b32_e64 v16, v17, v16, s[90:91]
    v_cndmask_b32_e64 v20, v16, v18, s[92:93]
    s_add_u32 s61, s60, 163840
    buffer_load_dwordx4 v[92:95], v2, s[12:15], s61 offen offset:2304 nt
    s_waitcnt vmcnt(63)
    v_mfma_f32_16x16x32_bf16 v[48:51], v[112:115], v[40:43], 0
    v_cndmask_b32_e64 v16, v57, v56, s[52:53]
    v_cndmask_b32_e64 v17, v59, v58, s[52:53]
    v_add_f32_dpp v22, v20, v20 quad_perm:[1,0,3,2] row_mask:0xf bank_mask:0xf
    s_mov_b64 exec, s[94:95]
    ds_write_b32 v13, v22 offset:896
    s_mov_b64 exec, -1
    v_mfma_f32_16x16x32_bf16 v[48:51], v[116:119], v[44:47], v[48:51]
    v_cndmask_b32_e64 v18, v17, v16, s[90:91]
    v_mfma_f32_16x16x32_bf16 v[52:55], v[120:123], v[40:43], 0
    v_cndmask_b32_e64 v16, v61, v60, s[52:53]
    v_cndmask_b32_e64 v17, v63, v62, s[52:53]
    v_mfma_f32_16x16x32_bf16 v[52:55], v[124:127], v[44:47], v[52:55]
    v_cndmask_b32_e64 v16, v17, v16, s[90:91]
    v_cndmask_b32_e64 v21, v16, v18, s[92:93]
    s_add_u32 s61, s60, 180224
    buffer_load_dwordx4 v[96:99], v2, s[12:15], s61 offen offset:0 nt
    s_waitcnt vmcnt(63)
    v_mfma_f32_16x16x32_bf16 v[56:59], v[128:131], v[40:43], 0
    v_cndmask_b32_e64 v16, v49, v48, s[52:53]
    v_cndmask_b32_e64 v17, v51, v50, s[52:53]
    v_add_f32_dpp v23, v21, v21 quad_perm:[1,0,3,2] row_mask:0xf bank_mask:0xf
    s_mov_b64 exec, s[94:95]
    ds_write_b32 v13, v23 offset:960
    s_mov_b64 exec, -1
    v_mfma_f32_16x16x32_bf16 v[56:59], v[132:135], v[44:47], v[56:59]
    v_cndmask_b32_e64 v18, v17, v16, s[90:91]
    v_mfma_f32_16x16x32_bf16 v[60:63], v[136:139], v[40:43], 0
    v_cndmask_b32_e64 v16, v53, v52, s[52:53]
    v_cndmask_b32_e64 v17, v55, v54, s[52:53]
    v_mfma_f32_16x16x32_bf16 v[60:63], v[140:143], v[44:47], v[60:63]
    v_cndmask_b32_e64 v16, v17, v16, s[90:91]
    v_cndmask_b32_e64 v20, v16, v18, s[92:93]
    s_add_u32 s61, s60, 180224
    buffer_load_dwordx4 v[100:103], v2, s[12:15], s61 offen offset:256 nt
    s_waitcnt vmcnt(63)
    v_mfma_f32_16x16x32_bf16 v[48:51], v[144:147], v[40:43], 0
    v_cndmask_b32_e64 v16, v57, v56, s[52:53]
    v_cndmask_b32_e64 v17, v59, v58, s[52:53]
    v_add_f32_dpp v22, v20, v20 quad_perm:[1,0,3,2] row_mask:0xf bank_mask:0xf
    s_mov_b64 exec, s[94:95]
    ds_write_b32 v13, v22 offset:1024
    s_mov_b64 exec, -1
    v_mfma_f32_16x16x32_bf16 v[48:51], v[148:151], v[44:47], v[48:51]
    v_cndmask_b32_e64 v18, v17, v16, s[90:91]
    v_mfma_f32_16x16x32_bf16 v[52:55], v[152:155], v[40:43], 0
    v_cndmask_b32_e64 v16, v61, v60, s[52:53]
    v_cndmask_b32_e64 v17, v63, v62, s[52:53]
    v_mfma_f32_16x16x32_bf16 v[52:55], v[156:159], v[44:47], v[52:55]
    v_cndmask_b32_e64 v16, v17, v16, s[90:91]
    v_cndmask_b32_e64 v21, v16, v18, s[92:93]
    s_add_u32 s61, s60, 180224
    buffer_load_dwordx4 v[104:107], v2, s[12:15], s61 offen offset:2048 nt
    s_waitcnt vmcnt(63)
    v_mfma_f32_16x16x32_bf16 v[56:59], v[160:163], v[40:43], 0
    v_cndmask_b32_e64 v16, v49, v48, s[52:53]
    v_cndmask_b32_e64 v17, v51, v50, s[52:53]
    v_add_f32_dpp v23, v21, v21 quad_perm:[1,0,3,2] row_mask:0xf bank_mask:0xf
    s_mov_b64 exec, s[94:95]
    ds_write_b32 v13, v23 offset:1088
    s_mov_b64 exec, -1
    v_mfma_f32_16x16x32_bf16 v[56:59], v[164:167], v[44:47], v[56:59]
    v_cndmask_b32_e64 v18, v17, v16, s[90:91]
    v_mfma_f32_16x16x32_bf16 v[60:63], v[168:171], v[40:43], 0
    v_cndmask_b32_e64 v16, v53, v52, s[52:53]
    v_cndmask_b32_e64 v17, v55, v54, s[52:53]
    v_mfma_f32_16x16x32_bf16 v[60:63], v[172:175], v[44:47], v[60:63]
    v_cndmask_b32_e64 v16, v17, v16, s[90:91]
    v_cndmask_b32_e64 v20, v16, v18, s[92:93]
    s_add_u32 s61, s60, 180224
    buffer_load_dwordx4 v[108:111], v2, s[12:15], s61 offen offset:2304 nt
    s_waitcnt vmcnt(63)
    v_mfma_f32_16x16x32_bf16 v[48:51], v[176:179], v[40:43], 0
    v_cndmask_b32_e64 v16, v57, v56, s[52:53]
    v_cndmask_b32_e64 v17, v59, v58, s[52:53]
    v_add_f32_dpp v22, v20, v20 quad_perm:[1,0,3,2] row_mask:0xf bank_mask:0xf
    s_mov_b64 exec, s[94:95]
    ds_write_b32 v13, v22 offset:1152
    s_mov_b64 exec, -1
    v_mfma_f32_16x16x32_bf16 v[48:51], v[180:183], v[44:47], v[48:51]
    v_cndmask_b32_e64 v18, v17, v16, s[90:91]
    v_mfma_f32_16x16x32_bf16 v[52:55], v[184:187], v[40:43], 0
    v_cndmask_b32_e64 v16, v61, v60, s[52:53]
    v_cndmask_b32_e64 v17, v63, v62, s[52:53]
    v_mfma_f32_16x16x32_bf16 v[52:55], v[188:191], v[44:47], v[52:55]
    v_cndmask_b32_e64 v16, v17, v16, s[90:91]
    v_cndmask_b32_e64 v21, v16, v18, s[92:93]
    s_waitcnt vmcnt(60)
    v_mfma_f32_16x16x32_bf16 v[56:59], v[192:195], v[40:43], 0
    v_cndmask_b32_e64 v16, v49, v48, s[52:53]
    v_cndmask_b32_e64 v17, v51, v50, s[52:53]
    v_add_f32_dpp v23, v21, v21 quad_perm:[1,0,3,2] row_mask:0xf bank_mask:0xf
    s_mov_b64 exec, s[94:95]
    ds_write_b32 v13, v23 offset:1216
    s_mov_b64 exec, -1
    v_mfma_f32_16x16x32_bf16 v[56:59], v[196:199], v[44:47], v[56:59]
    v_cndmask_b32_e64 v18, v17, v16, s[90:91]
    v_mfma_f32_16x16x32_bf16 v[60:63], v[200:203], v[40:43], 0
    v_cndmask_b32_e64 v16, v53, v52, s[52:53]
    v_cndmask_b32_e64 v17, v55, v54, s[52:53]
    v_mfma_f32_16x16x32_bf16 v[60:63], v[204:207], v[44:47], v[60:63]
    v_cndmask_b32_e64 v16, v17, v16, s[90:91]
    v_cndmask_b32_e64 v20, v16, v18, s[92:93]
    s_waitcnt vmcnt(56)
    v_mfma_f32_16x16x32_bf16 v[48:51], v[208:211], v[40:43], 0
    v_cndmask_b32_e64 v16, v57, v56, s[52:53]
    v_cndmask_b32_e64 v17, v59, v58, s[52:53]
    v_add_f32_dpp v22, v20, v20 quad_perm:[1,0,3,2] row_mask:0xf bank_mask:0xf
    s_mov_b64 exec, s[94:95]
    ds_write_b32 v13, v22 offset:1280
    s_mov_b64 exec, -1
    v_mfma_f32_16x16x32_bf16 v[48:51], v[212:215], v[44:47], v[48:51]
    v_cndmask_b32_e64 v18, v17, v16, s[90:91]
    v_mfma_f32_16x16x32_bf16 v[52:55], v[216:219], v[40:43], 0
    v_cndmask_b32_e64 v16, v61, v60, s[52:53]
    v_cndmask_b32_e64 v17, v63, v62, s[52:53]
    v_mfma_f32_16x16x32_bf16 v[52:55], v[220:223], v[44:47], v[52:55]
    v_cndmask_b32_e64 v16, v17, v16, s[90:91]
    v_cndmask_b32_e64 v21, v16, v18, s[92:93]
    s_waitcnt vmcnt(52)
    v_mfma_f32_16x16x32_bf16 v[56:59], v[224:227], v[40:43], 0
    v_cndmask_b32_e64 v16, v49, v48, s[52:53]
    v_cndmask_b32_e64 v17, v51, v50, s[52:53]
    v_add_f32_dpp v23, v21, v21 quad_perm:[1,0,3,2] row_mask:0xf bank_mask:0xf
    s_mov_b64 exec, s[94:95]
    ds_write_b32 v13, v23 offset:1344
    s_mov_b64 exec, -1
    v_mfma_f32_16x16x32_bf16 v[56:59], v[228:231], v[44:47], v[56:59]
    v_cndmask_b32_e64 v18, v17, v16, s[90:91]
    v_mfma_f32_16x16x32_bf16 v[60:63], v[232:235], v[40:43], 0
    v_cndmask_b32_e64 v16, v53, v52, s[52:53]
    v_cndmask_b32_e64 v17, v55, v54, s[52:53]
    v_mfma_f32_16x16x32_bf16 v[60:63], v[236:239], v[44:47], v[60:63]
    v_cndmask_b32_e64 v16, v17, v16, s[90:91]
    v_cndmask_b32_e64 v20, v16, v18, s[92:93]
    s_waitcnt vmcnt(48)
    v_mfma_f32_16x16x32_bf16 v[48:51], v[240:243], v[40:43], 0
    v_cndmask_b32_e64 v16, v57, v56, s[52:53]
    v_cndmask_b32_e64 v17, v59, v58, s[52:53]
    v_add_f32_dpp v22, v20, v20 quad_perm:[1,0,3,2] row_mask:0xf bank_mask:0xf
    s_mov_b64 exec, s[94:95]
    ds_write_b32 v13, v22 offset:1408
    s_mov_b64 exec, -1
    v_mfma_f32_16x16x32_bf16 v[48:51], v[244:247], v[44:47], v[48:51]
    v_cndmask_b32_e64 v18, v17, v16, s[90:91]
    v_mfma_f32_16x16x32_bf16 v[52:55], v[248:251], v[40:43], 0
    v_cndmask_b32_e64 v16, v61, v60, s[52:53]
    v_cndmask_b32_e64 v17, v63, v62, s[52:53]
    v_mfma_f32_16x16x32_bf16 v[52:55], v[252:255], v[44:47], v[52:55]
    v_cndmask_b32_e64 v16, v17, v16, s[90:91]
    v_cndmask_b32_e64 v21, v16, v18, s[92:93]
    s_nop 7
    s_nop 3
    v_cndmask_b32_e64 v16, v49, v48, s[52:53]
    v_cndmask_b32_e64 v17, v51, v50, s[52:53]
    v_add_f32_dpp v23, v21, v21 quad_perm:[1,0,3,2] row_mask:0xf bank_mask:0xf
    s_mov_b64 exec, s[94:95]
    ds_write_b32 v13, v23 offset:1472
    s_mov_b64 exec, -1
    v_cndmask_b32_e64 v18, v17, v16, s[90:91]
    v_cndmask_b32_e64 v16, v53, v52, s[52:53]
    v_cndmask_b32_e64 v17, v55, v54, s[52:53]
    v_cndmask_b32_e64 v16, v17, v16, s[90:91]
    v_cndmask_b32_e64 v20, v16, v18, s[92:93]
    s_nop 1
    v_add_f32_dpp v22, v20, v20 quad_perm:[1,0,3,2] row_mask:0xf bank_mask:0xf
    s_mov_b64 exec, s[94:95]
    ds_write_b32 v13, v22 offset:1536
    s_mov_b64 exec, -1
    s_waitcnt vmcnt(48)
    v_cmp_ne_u32 vcc, s6, v12
    s_cmp_eq_u64 vcc, 0
    s_cselect_b32 s7, 1, 0
    s_branch L_EXP
L_PASS:
    s_waitcnt lgkmcnt(0)
    s_barrier
    v_lshrrev_b32 v13, 4, v1
    v_lshlrev_b32 v13, 5, v13
    v_and_b32 v14, 1, v1
    v_lshl_add_u32 v13, v14, 4, v13
    ds_read_b128 v[40:43], v13 offset:8960
    ds_read_b128 v[44:47], v13 offset:9088
    s_add_u32 s61, s60, 147456
    buffer_load_dwordx4 v[64:67], v2, s[12:15], s61 offen offset:0 nt
    buffer_load_dwordx4 v[68:71], v2, s[12:15], s61 offen offset:256 nt
    buffer_load_dwordx4 v[72:75], v2, s[12:15], s61 offen offset:2048 nt
    buffer_load_dwordx4 v[76:79], v2, s[12:15], s61 offen offset:2304 nt
    s_add_u32 s61, s60, 163840
    buffer_load_dwordx4 v[80:83], v2, s[12:15], s61 offen offset:0 nt
    buffer_load_dwordx4 v[84:87], v2, s[12:15], s61 offen offset:256 nt
    buffer_load_dwordx4 v[88:91], v2, s[12:15], s61 offen offset:2048 nt
    buffer_load_dwordx4 v[92:95], v2, s[12:15], s61 offen offset:2304 nt
    s_add_u32 s61, s60, 180224
    buffer_load_dwordx4 v[96:99], v2, s[12:15], s61 offen offset:0 nt
    buffer_load_dwordx4 v[100:103], v2, s[12:15], s61 offen offset:256 nt
    buffer_load_dwordx4 v[104:107], v2, s[12:15], s61 offen offset:2048 nt
    buffer_load_dwordx4 v[108:111], v2, s[12:15], s61 offen offset:2304 nt
    v_bfe_u32 v13, v1, 1, 2
    v_lshl_add_u32 v13, v13, 2, v8
    s_waitcnt lgkmcnt(0)
    v_mfma_f32_16x16x32_bf16 v[48:51], a[0:3], v[40:43], 0
    s_nop 1
    v_mfma_f32_16x16x32_bf16 v[48:51], a[4:7], v[44:47], v[48:51]
    v_mfma_f32_16x16x32_bf16 v[52:55], a[8:11], v[40:43], 0
    v_mfma_f32_16x16x32_bf16 v[52:55], a[12:15], v[44:47], v[52:55]
    s_nop 7
    s_nop 3
    v_mfma_f32_16x16x32_bf16 v[56:59], a[16:19], v[40:43], 0
    v_cndmask_b32_e64 v16, v49, v48, s[52:53]
    v_cndmask_b32_e64 v17, v51, v50, s[52:53]
    v_mfma_f32_16x16x32_bf16 v[56:59], a[20:23], v[44:47], v[56:59]
    v_cndmask_b32_e64 v18, v17, v16, s[90:91]
    v_mfma_f32_16x16x32_bf16 v[60:63], a[24:27], v[40:43], 0
    v_cndmask_b32_e64 v16, v53, v52, s[52:53]
    v_cndmask_b32_e64 v17, v55, v54, s[52:53]
    v_mfma_f32_16x16x32_bf16 v[60:63], a[28:31], v[44:47], v[60:63]
    v_cndmask_b32_e64 v16, v17, v16, s[90:91]
    v_cndmask_b32_e64 v20, v16, v18, s[92:93]
    v_mfma_f32_16x16x32_bf16 v[48:51], a[32:35], v[40:43], 0
    v_cndmask_b32_e64 v16, v57, v56, s[52:53]
    v_cndmask_b32_e64 v17, v59, v58, s[52:53]
    v_add_f32_dpp v22, v20, v20 quad_perm:[1,0,3,2] row_mask:0xf bank_mask:0xf
    s_mov_b64 exec, s[94:95]
    ds_write_b32 v13, v22 offset:0
    s_mov_b64 exec, -1
    v_mfma_f32_16x16x32_bf16 v[48:51], a[36:39], v[44:47], v[48:51]
    v_cndmask_b32_e64 v18, v17, v16, s[90:91]
    v_mfma_f32_16x16x32_bf16 v[52:55], a[40:43], v[40:43], 0
    v_cndmask_b32_e64 v16, v61, v60, s[52:53]
    v_cndmask_b32_e64 v17, v63, v62, s[52:53]
    v_mfma_f32_16x16x32_bf16 v[52:55], a[44:47], v[44:47], v[52:55]
    v_cndmask_b32_e64 v16, v17, v16, s[90:91]
    v_cndmask_b32_e64 v21, v16, v18, s[92:93]
    v_mfma_f32_16x16x32_bf16 v[56:59], a[48:51], v[40:43], 0
    v_cndmask_b32_e64 v16, v49, v48, s[52:53]
    v_cndmask_b32_e64 v17, v51, v50, s[52:53]
    v_add_f32_dpp v23, v21, v21 quad_perm:[1,0,3,2] row_mask:0xf bank_mask:0xf
    s_mov_b64 exec, s[94:95]
    ds_write_b32 v13, v23 offset:64
    s_mov_b64 exec, -1
    v_mfma_f32_16x16x32_bf16 v[56:59], a[52:55], v[44:47], v[56:59]
    v_cndmask_b32_e64 v18, v17, v16, s[90:91]
    v_mfma_f32_16x16x32_bf16 v[60:63], a[56:59], v[40:43], 0
    v_cndmask_b32_e64 v16, v53, v52, s[52:53]
    v_cndmask_b32_e64 v17, v55, v54, s[52:53]
    v_mfma_f32_16x16x32_bf16 v[60:63], a[60:63], v[44:47], v[60:63]
    v_cndmask_b32_e64 v16, v17, v16, s[90:91]
    v_cndmask_b32_e64 v20, v16, v18, s[92:93]
    v_mfma_f32_16x16x32_bf16 v[48:51], a[64:67], v[40:43], 0
    v_cndmask_b32_e64 v16, v57, v56, s[52:53]
    v_cndmask_b32_e64 v17, v59, v58, s[52:53]
    v_add_f32_dpp v22, v20, v20 quad_perm:[1,0,3,2] row_mask:0xf bank_mask:0xf
    s_mov_b64 exec, s[94:95]
    ds_write_b32 v13, v22 offset:128
    s_mov_b64 exec, -1
    v_mfma_f32_16x16x32_bf16 v[48:51], a[68:71], v[44:47], v[48:51]
    v_cndmask_b32_e64 v18, v17, v16, s[90:91]
    v_mfma_f32_16x16x32_bf16 v[52:55], a[72:75], v[40:43], 0
    v_cndmask_b32_e64 v16, v61, v60, s[52:53]
    v_cndmask_b32_e64 v17, v63, v62, s[52:53]
    v_mfma_f32_16x16x32_bf16 v[52:55], a[76:79], v[44:47], v[52:55]
    v_cndmask_b32_e64 v16, v17, v16, s[90:91]
    v_cndmask_b32_e64 v21, v16, v18, s[92:93]
    v_mfma_f32_16x16x32_bf16 v[56:59], a[80:83], v[40:43], 0
    v_cndmask_b32_e64 v16, v49, v48, s[52:53]
    v_cndmask_b32_e64 v17, v51, v50, s[52:53]
    v_add_f32_dpp v23, v21, v21 quad_perm:[1,0,3,2] row_mask:0xf bank_mask:0xf
    s_mov_b64 exec, s[94:95]
    ds_write_b32 v13, v23 offset:192
    s_mov_b64 exec, -1
    v_mfma_f32_16x16x32_bf16 v[56:59], a[84:87], v[44:47], v[56:59]
    v_cndmask_b32_e64 v18, v17, v16, s[90:91]
    v_mfma_f32_16x16x32_bf16 v[60:63], a[88:91], v[40:43], 0
    v_cndmask_b32_e64 v16, v53, v52, s[52:53]
    v_cndmask_b32_e64 v17, v55, v54, s[52:53]
    v_mfma_f32_16x16x32_bf16 v[60:63], a[92:95], v[44:47], v[60:63]
    v_cndmask_b32_e64 v16, v17, v16, s[90:91]
    v_cndmask_b32_e64 v20, v16, v18, s[92:93]
    v_mfma_f32_16x16x32_bf16 v[48:51], a[96:99], v[40:43], 0
    v_cndmask_b32_e64 v16, v57, v56, s[52:53]
    v_cndmask_b32_e64 v17, v59, v58, s[52:53]
    v_add_f32_dpp v22, v20, v20 quad_perm:[1,0,3,2] row_mask:0xf bank_mask:0xf
    s_mov_b64 exec, s[94:95]
    ds_write_b32 v13, v22 offset:256
    s_mov_b64 exec, -1
    v_mfma_f32_16x16x32_bf16 v[48:51], a[100:103], v[44:47], v[48:51]
    v_cndmask_b32_e64 v18, v17, v16, s[90:91]
    v_mfma_f32_16x16x32_bf16 v[52:55], a[104:107], v[40:43], 0
    v_cndmask_b32_e64 v16, v61, v60, s[52:53]
    v_cndmask_b32_e64 v17, v63, v62, s[52:53]
    v_mfma_f32_16x16x32_bf16 v[52:55], a[108:111], v[44:47], v[52:55]
    v_cndmask_b32_e64 v16, v17, v16, s[90:91]
    v_cndmask_b32_e64 v21, v16, v18, s[92:93]
    v_mfma_f32_16x16x32_bf16 v[56:59], a[112:115], v[40:43], 0
    v_cndmask_b32_e64 v16, v49, v48, s[52:53]
    v_cndmask_b32_e64 v17, v51, v50, s[52:53]
    v_add_f32_dpp v23, v21, v21 quad_perm:[1,0,3,2] row_mask:0xf bank_mask:0xf
    s_mov_b64 exec, s[94:95]
    ds_write_b32 v13, v23 offset:320
    s_mov_b64 exec, -1
    v_mfma_f32_16x16x32_bf16 v[56:59], a[116:119], v[44:47], v[56:59]
    v_cndmask_b32_e64 v18, v17, v16, s[90:91]
    v_mfma_f32_16x16x32_bf16 v[60:63], a[120:123], v[40:43], 0
    v_cndmask_b32_e64 v16, v53, v52, s[52:53]
    v_cndmask_b32_e64 v17, v55, v54, s[52:53]
    v_mfma_f32_16x16x32_bf16 v[60:63], a[124:127], v[44:47], v[60:63]
    v_cndmask_b32_e64 v16, v17, v16, s[90:91]
    v_cndmask_b32_e64 v20, v16, v18, s[92:93]
    v_mfma_f32_16x16x32_bf16 v[48:51], a[128:131], v[40:43], 0
    v_cndmask_b32_e64 v16, v57, v56, s[52:53]
    v_cndmask_b32_e64 v17, v59, v58, s[52:53]
    v_add_f32_dpp v22, v20, v20 quad_perm:[1,0,3,2] row_mask:0xf bank_mask:0xf
    s_mov_b64 exec, s[94:95]
    ds_write_b32 v13, v22 offset:384
    s_mov_b64 exec, -1
    v_mfma_f32_16x16x32_bf16 v[48:51], a[132:135], v[44:47], v[48:51]
    v_cndmask_b32_e64 v18, v17, v16, s[90:91]
    v_mfma_f32_16x16x32_bf16 v[52:55], a[136:139], v[40:43], 0
    v_cndmask_b32_e64 v16, v61, v60, s[52:53]
    v_cndmask_b32_e64 v17, v63, v62, s[52:53]
    v_mfma_f32_16x16x32_bf16 v[52:55], a[140:143], v[44:47], v[52:55]
    v_cndmask_b32_e64 v16, v17, v16, s[90:91]
    v_cndmask_b32_e64 v21, v16, v18, s[92:93]
    v_mfma_f32_16x16x32_bf16 v[56:59], a[144:147], v[40:43], 0
    v_cndmask_b32_e64 v16, v49, v48, s[52:53]
    v_cndmask_b32_e64 v17, v51, v50, s[52:53]
    v_add_f32_dpp v23, v21, v21 quad_perm:[1,0,3,2] row_mask:0xf bank_mask:0xf
    s_mov_b64 exec, s[94:95]
    ds_write_b32 v13, v23 offset:448
    s_mov_b64 exec, -1
    v_mfma_f32_16x16x32_bf16 v[56:59], a[148:151], v[44:47], v[56:59]
    v_cndmask_b32_e64 v18, v17, v16, s[90:91]
    v_mfma_f32_16x16x32_bf16 v[60:63], a[152:155], v[40:43], 0
    v_cndmask_b32_e64 v16, v53, v52, s[52:53]
    v_cndmask_b32_e64 v17, v55, v54, s[52:53]
    v_mfma_f32_16x16x32_bf16 v[60:63], a[156:159], v[44:47], v[60:63]
    v_cndmask_b32_e64 v16, v17, v16, s[90:91]
    v_cndmask_b32_e64 v20, v16, v18, s[92:93]
    v_mfma_f32_16x16x32_bf16 v[48:51], a[160:163], v[40:43], 0
    v_cndmask_b32_e64 v16, v57, v56, s[52:53]
    v_cndmask_b32_e64 v17, v59, v58, s[52:53]
    v_add_f32_dpp v22, v20, v20 quad_perm:[1,0,3,2] row_mask:0xf bank_mask:0xf
    s_mov_b64 exec, s[94:95]
    ds_write_b32 v13, v22 offset:512
    s_mov_b64 exec, -1
    v_mfma_f32_16x16x32_bf16 v[48:51], a[164:167], v[44:47], v[48:51]
    v_cndmask_b32_e64 v18, v17, v16, s[90:91]
    v_mfma_f32_16x16x32_bf16 v[52:55], a[168:171], v[40:43], 0
    v_cndmask_b32_e64 v16, v61, v60, s[52:53]
    v_cndmask_b32_e64 v17, v63, v62, s[52:53]
    v_mfma_f32_16x16x32_bf16 v[52:55], a[172:175], v[44:47], v[52:55]
    v_cndmask_b32_e64 v16, v17, v16, s[90:91]
    v_cndmask_b32_e64 v21, v16, v18, s[92:93]
    v_mfma_f32_16x16x32_bf16 v[56:59], a[176:179], v[40:43], 0
    v_cndmask_b32_e64 v16, v49, v48, s[52:53]
    v_cndmask_b32_e64 v17, v51, v50, s[52:53]
    v_add_f32_dpp v23, v21, v21 quad_perm:[1,0,3,2] row_mask:0xf bank_mask:0xf
    s_mov_b64 exec, s[94:95]
    ds_write_b32 v13, v23 offset:576
    s_mov_b64 exec, -1
    v_mfma_f32_16x16x32_bf16 v[56:59], a[180:183], v[44:47], v[56:59]
    v_cndmask_b32_e64 v18, v17, v16, s[90:91]
    v_mfma_f32_16x16x32_bf16 v[60:63], a[184:187], v[40:43], 0
    v_cndmask_b32_e64 v16, v53, v52, s[52:53]
    v_cndmask_b32_e64 v17, v55, v54, s[52:53]
    v_mfma_f32_16x16x32_bf16 v[60:63], a[188:191], v[44:47], v[60:63]
    v_cndmask_b32_e64 v16, v17, v16, s[90:91]
    v_cndmask_b32_e64 v20, v16, v18, s[92:93]
    v_mfma_f32_16x16x32_bf16 v[48:51], a[192:195], v[40:43], 0
    v_cndmask_b32_e64 v16, v57, v56, s[52:53]
    v_cndmask_b32_e64 v17, v59, v58, s[52:53]
    v_add_f32_dpp v22, v20, v20 quad_perm:[1,0,3,2] row_mask:0xf bank_mask:0xf
    s_mov_b64 exec, s[94:95]
    ds_write_b32 v13, v22 offset:640
    s_mov_b64 exec, -1
    v_mfma_f32_16x16x32_bf16 v[48:51], a[196:199], v[44:47], v[48:51]
    v_cndmask_b32_e64 v18, v17, v16, s[90:91]
    v_mfma_f32_16x16x32_bf16 v[52:55], a[200:203], v[40:43], 0
    v_cndmask_b32_e64 v16, v61, v60, s[52:53]
    v_cndmask_b32_e64 v17, v63, v62, s[52:53]
    v_mfma_f32_16x16x32_bf16 v[52:55], a[204:207], v[44:47], v[52:55]
    v_cndmask_b32_e64 v16, v17, v16, s[90:91]
    v_cndmask_b32_e64 v21, v16, v18, s[92:93]
    v_mfma_f32_16x16x32_bf16 v[56:59], a[208:211], v[40:43], 0
    v_cndmask_b32_e64 v16, v49, v48, s[52:53]
    v_cndmask_b32_e64 v17, v51, v50, s[52:53]
    v_add_f32_dpp v23, v21, v21 quad_perm:[1,0,3,2] row_mask:0xf bank_mask:0xf
    s_mov_b64 exec, s[94:95]
    ds_write_b32 v13, v23 offset:704
    s_mov_b64 exec, -1
    v_mfma_f32_16x16x32_bf16 v[56:59], a[212:215], v[44:47], v[56:59]
    v_cndmask_b32_e64 v18, v17, v16, s[90:91]
    v_mfma_f32_16x16x32_bf16 v[60:63], a[216:219], v[40:43], 0
    v_cndmask_b32_e64 v16, v53, v52, s[52:53]
    v_cndmask_b32_e64 v17, v55, v54, s[52:53]
    v_mfma_f32_16x16x32_bf16 v[60:63], a[220:223], v[44:47], v[60:63]
    v_cndmask_b32_e64 v16, v17, v16, s[90:91]
    v_cndmask_b32_e64 v20, v16, v18, s[92:93]
    v_mfma_f32_16x16x32_bf16 v[48:51], a[224:227], v[40:43], 0
    v_cndmask_b32_e64 v16, v57, v56, s[52:53]
    v_cndmask_b32_e64 v17, v59, v58, s[52:53]
    v_add_f32_dpp v22, v20, v20 quad_perm:[1,0,3,2] row_mask:0xf bank_mask:0xf
    s_mov_b64 exec, s[94:95]
    ds_write_b32 v13, v22 offset:768
    s_mov_b64 exec, -1
    v_mfma_f32_16x16x32_bf16 v[48:51], a[228:231], v[44:47], v[48:51]
    v_cndmask_b32_e64 v18, v17, v16, s[90:91]
    v_mfma_f32_16x16x32_bf16 v[52:55], a[232:235], v[40:43], 0
    v_cndmask_b32_e64 v16, v61, v60, s[52:53]
    v_cndmask_b32_e64 v17, v63, v62, s[52:53]
    v_mfma_f32_16x16x32_bf16 v[52:55], a[236:239], v[44:47], v[52:55]
    v_cndmask_b32_e64 v16, v17, v16, s[90:91]
    v_cndmask_b32_e64 v21, v16, v18, s[92:93]
    v_mfma_f32_16x16x32_bf16 v[56:59], a[240:243], v[40:43], 0
    v_cndmask_b32_e64 v16, v49, v48, s[52:53]
    v_cndmask_b32_e64 v17, v51, v50, s[52:53]
    v_add_f32_dpp v23, v21, v21 quad_perm:[1,0,3,2] row_mask:0xf bank_mask:0xf
    s_mov_b64 exec, s[94:95]
    ds_write_b32 v13, v23 offset:832
    s_mov_b64 exec, -1
    v_mfma_f32_16x16x32_bf16 v[56:59], a[244:247], v[44:47], v[56:59]
    v_cndmask_b32_e64 v18, v17, v16, s[90:91]
    v_mfma_f32_16x16x32_bf16 v[60:63], a[248:251], v[40:43], 0
    v_cndmask_b32_e64 v16, v53, v52, s[52:53]
    v_cndmask_b32_e64 v17, v55, v54, s[52:53]
    v_mfma_f32_16x16x32_bf16 v[60:63], a[252:255], v[44:47], v[60:63]
    v_cndmask_b32_e64 v16, v17, v16, s[90:91]
    v_cndmask_b32_e64 v20, v16, v18, s[92:93]
    v_mfma_f32_16x16x32_bf16 v[48:51], v[112:115], v[40:43], 0
    v_cndmask_b32_e64 v16, v57, v56, s[52:53]
    v_cndmask_b32_e64 v17, v59, v58, s[52:53]
    v_add_f32_dpp v22, v20, v20 quad_perm:[1,0,3,2] row_mask:0xf bank_mask:0xf
    s_mov_b64 exec, s[94:95]
    ds_write_b32 v13, v22 offset:896
    s_mov_b64 exec, -1
    v_mfma_f32_16x16x32_bf16 v[48:51], v[116:119], v[44:47], v[48:51]
    v_cndmask_b32_e64 v18, v17, v16, s[90:91]
    v_mfma_f32_16x16x32_bf16 v[52:55], v[120:123], v[40:43], 0
    v_cndmask_b32_e64 v16, v61, v60, s[52:53]
    v_cndmask_b32_e64 v17, v63, v62, s[52:53]
    v_mfma_f32_16x16x32_bf16 v[52:55], v[124:127], v[44:47], v[52:55]
    v_cndmask_b32_e64 v16, v17, v16, s[90:91]
    v_cndmask_b32_e64 v21, v16, v18, s[92:93]
    v_mfma_f32_16x16x32_bf16 v[56:59], v[128:131], v[40:43], 0
    v_cndmask_b32_e64 v16, v49, v48, s[52:53]
    v_cndmask_b32_e64 v17, v51, v50, s[52:53]
    v_add_f32_dpp v23, v21, v21 quad_perm:[1,0,3,2] row_mask:0xf bank_mask:0xf
    s_mov_b64 exec, s[94:95]
    ds_write_b32 v13, v23 offset:960
    s_mov_b64 exec, -1
    v_mfma_f32_16x16x32_bf16 v[56:59], v[132:135], v[44:47], v[56:59]
    v_cndmask_b32_e64 v18, v17, v16, s[90:91]
    v_mfma_f32_16x16x32_bf16 v[60:63], v[136:139], v[40:43], 0
    v_cndmask_b32_e64 v16, v53, v52, s[52:53]
    v_cndmask_b32_e64 v17, v55, v54, s[52:53]
    v_mfma_f32_16x16x32_bf16 v[60:63], v[140:143], v[44:47], v[60:63]
    v_cndmask_b32_e64 v16, v17, v16, s[90:91]
    v_cndmask_b32_e64 v20, v16, v18, s[92:93]
    v_mfma_f32_16x16x32_bf16 v[48:51], v[144:147], v[40:43], 0
    v_cndmask_b32_e64 v16, v57, v56, s[52:53]
    v_cndmask_b32_e64 v17, v59, v58, s[52:53]
    v_add_f32_dpp v22, v20, v20 quad_perm:[1,0,3,2] row_mask:0xf bank_mask:0xf
    s_mov_b64 exec, s[94:95]
    ds_write_b32 v13, v22 offset:1024
    s_mov_b64 exec, -1
    v_mfma_f32_16x16x32_bf16 v[48:51], v[148:151], v[44:47], v[48:51]
    v_cndmask_b32_e64 v18, v17, v16, s[90:91]
    v_mfma_f32_16x16x32_bf16 v[52:55], v[152:155], v[40:43], 0
    v_cndmask_b32_e64 v16, v61, v60, s[52:53]
    v_cndmask_b32_e64 v17, v63, v62, s[52:53]
    v_mfma_f32_16x16x32_bf16 v[52:55], v[156:159], v[44:47], v[52:55]
    v_cndmask_b32_e64 v16, v17, v16, s[90:91]
    v_cndmask_b32_e64 v21, v16, v18, s[92:93]
    v_mfma_f32_16x16x32_bf16 v[56:59], v[160:163], v[40:43], 0
    v_cndmask_b32_e64 v16, v49, v48, s[52:53]
    v_cndmask_b32_e64 v17, v51, v50, s[52:53]
    v_add_f32_dpp v23, v21, v21 quad_perm:[1,0,3,2] row_mask:0xf bank_mask:0xf
    s_mov_b64 exec, s[94:95]
    ds_write_b32 v13, v23 offset:1088
    s_mov_b64 exec, -1
    v_mfma_f32_16x16x32_bf16 v[56:59], v[164:167], v[44:47], v[56:59]
    v_cndmask_b32_e64 v18, v17, v16, s[90:91]
    v_mfma_f32_16x16x32_bf16 v[60:63], v[168:171], v[40:43], 0
    v_cndmask_b32_e64 v16, v53, v52, s[52:53]
    v_cndmask_b32_e64 v17, v55, v54, s[52:53]
    v_mfma_f32_16x16x32_bf16 v[60:63], v[172:175], v[44:47], v[60:63]
    v_cndmask_b32_e64 v16, v17, v16, s[90:91]
    v_cndmask_b32_e64 v20, v16, v18, s[92:93]
    v_mfma_f32_16x16x32_bf16 v[48:51], v[176:179], v[40:43], 0
    v_cndmask_b32_e64 v16, v57, v56, s[52:53]
    v_cndmask_b32_e64 v17, v59, v58, s[52:53]
    v_add_f32_dpp v22, v20, v20 quad_perm:[1,0,3,2] row_mask:0xf bank_mask:0xf
    s_mov_b64 exec, s[94:95]
    ds_write_b32 v13, v22 offset:1152
    s_mov_b64 exec, -1
    v_mfma_f32_16x16x32_bf16 v[48:51], v[180:183], v[44:47], v[48:51]
    v_cndmask_b32_e64 v18, v17, v16, s[90:91]
    v_mfma_f32_16x16x32_bf16 v[52:55], v[184:187], v[40:43], 0
    v_cndmask_b32_e64 v16, v61, v60, s[52:53]
    v_cndmask_b32_e64 v17, v63, v62, s[52:53]
    v_mfma_f32_16x16x32_bf16 v[52:55], v[188:191], v[44:47], v[52:55]
    v_cndmask_b32_e64 v16, v17, v16, s[90:91]
    v_cndmask_b32_e64 v21, v16, v18, s[92:93]
    v_mfma_f32_16x16x32_bf16 v[56:59], v[192:195], v[40:43], 0
    v_cndmask_b32_e64 v16, v49, v48, s[52:53]
    v_cndmask_b32_e64 v17, v51, v50, s[52:53]
    v_add_f32_dpp v23, v21, v21 quad_perm:[1,0,3,2] row_mask:0xf bank_mask:0xf
    s_mov_b64 exec, s[94:95]
    ds_write_b32 v13, v23 offset:1216
    s_mov_b64 exec, -1
    v_mfma_f32_16x16x32_bf16 v[56:59], v[196:199], v[44:47], v[56:59]
    v_cndmask_b32_e64 v18, v17, v16, s[90:91]
    v_mfma_f32_16x16x32_bf16 v[60:63], v[200:203], v[40:43], 0
    v_cndmask_b32_e64 v16, v53, v52, s[52:53]
    v_cndmask_b32_e64 v17, v55, v54, s[52:53]
    v_mfma_f32_16x16x32_bf16 v[60:63], v[204:207], v[44:47], v[60:63]
    v_cndmask_b32_e64 v16, v17, v16, s[90:91]
    v_cndmask_b32_e64 v20, v16, v18, s[92:93]
    v_mfma_f32_16x16x32_bf16 v[48:51], v[208:211], v[40:43], 0
    v_cndmask_b32_e64 v16, v57, v56, s[52:53]
    v_cndmask_b32_e64 v17, v59, v58, s[52:53]
    v_add_f32_dpp v22, v20, v20 quad_perm:[1,0,3,2] row_mask:0xf bank_mask:0xf
    s_mov_b64 exec, s[94:95]
    ds_write_b32 v13, v22 offset:1280
    s_mov_b64 exec, -1
    v_mfma_f32_16x16x32_bf16 v[48:51], v[212:215], v[44:47], v[48:51]
    v_cndmask_b32_e64 v18, v17, v16, s[90:91]
    v_mfma_f32_16x16x32_bf16 v[52:55], v[216:219], v[40:43], 0
    v_cndmask_b32_e64 v16, v61, v60, s[52:53]
    v_cndmask_b32_e64 v17, v63, v62, s[52:53]
    v_mfma_f32_16x16x32_bf16 v[52:55], v[220:223], v[44:47], v[52:55]
    v_cndmask_b32_e64 v16, v17, v16, s[90:91]
    v_cndmask_b32_e64 v21, v16, v18, s[92:93]
    v_mfma_f32_16x16x32_bf16 v[56:59], v[224:227], v[40:43], 0
    v_cndmask_b32_e64 v16, v49, v48, s[52:53]
    v_cndmask_b32_e64 v17, v51, v50, s[52:53]
    v_add_f32_dpp v23, v21, v21 quad_perm:[1,0,3,2] row_mask:0xf bank_mask:0xf
    s_mov_b64 exec, s[94:95]
    ds_write_b32 v13, v23 offset:1344
    s_mov_b64 exec, -1
    v_mfma_f32_16x16x32_bf16 v[56:59], v[228:231], v[44:47], v[56:59]
    v_cndmask_b32_e64 v18, v17, v16, s[90:91]
    v_mfma_f32_16x16x32_bf16 v[60:63], v[232:235], v[40:43], 0
    v_cndmask_b32_e64 v16, v53, v52, s[52:53]
    v_cndmask_b32_e64 v17, v55, v54, s[52:53]
    v_mfma_f32_16x16x32_bf16 v[60:63], v[236:239], v[44:47], v[60:63]
    v_cndmask_b32_e64 v16, v17, v16, s[90:91]
    v_cndmask_b32_e64 v20, v16, v18, s[92:93]
    v_mfma_f32_16x16x32_bf16 v[48:51], v[240:243], v[40:43], 0
    v_cndmask_b32_e64 v16, v57, v56, s[52:53]
    v_cndmask_b32_e64 v17, v59, v58, s[52:53]
    v_add_f32_dpp v22, v20, v20 quad_perm:[1,0,3,2] row_mask:0xf bank_mask:0xf
    s_mov_b64 exec, s[94:95]
    ds_write_b32 v13, v22 offset:1408
    s_mov_b64 exec, -1
    v_mfma_f32_16x16x32_bf16 v[48:51], v[244:247], v[44:47], v[48:51]
    v_cndmask_b32_e64 v18, v17, v16, s[90:91]
    v_mfma_f32_16x16x32_bf16 v[52:55], v[248:251], v[40:43], 0
    v_cndmask_b32_e64 v16, v61, v60, s[52:53]
    v_cndmask_b32_e64 v17, v63, v62, s[52:53]
    v_mfma_f32_16x16x32_bf16 v[52:55], v[252:255], v[44:47], v[52:55]
    v_cndmask_b32_e64 v16, v17, v16, s[90:91]
    v_cndmask_b32_e64 v21, v16, v18, s[92:93]
    s_nop 7
    s_nop 3
    v_cndmask_b32_e64 v16, v49, v48, s[52:53]
    v_cndmask_b32_e64 v17, v51, v50, s[52:53]
    v_add_f32_dpp v23, v21, v21 quad_perm:[1,0,3,2] row_mask:0xf bank_mask:0xf
    s_mov_b64 exec, s[94:95]
    ds_write_b32 v13, v23 offset:1472
    s_mov_b64 exec, -1
    v_cndmask_b32_e64 v18, v17, v16, s[90:91]
    v_cndmask_b32_e64 v16, v53, v52, s[52:53]
    v_cndmask_b32_e64 v17, v55, v54, s[52:53]
    v_cndmask_b32_e64 v16, v17, v16, s[90:91]
    v_cndmask_b32_e64 v20, v16, v18, s[92:93]
    s_nop 1
    v_add_f32_dpp v22, v20, v20 quad_perm:[1,0,3,2] row_mask:0xf bank_mask:0xf
    s_mov_b64 exec, s[94:95]
    ds_write_b32 v13, v22 offset:1536
    s_mov_b64 exec, -1
L_EXP:
    s_lshl_b32 s69, s3, 11
    v_lshlrev_b32 v13, 5, v1
    v_add_u32 v13, s69, v13
    v_mov_b32 v48, 0xff800000
    v_mov_b32 v49, 0xff800000
    v_mov_b32 v50, 0xff800000
    v_mov_b32 v51, 0xff800000
    v_mov_b32 v52, 0xff800000
    v_mov_b32 v53, 0xff800000
    v_mov_b32 v54, 0xff800000
    v_mov_b32 v55, 0xff800000
    s_mov_b32 s80, -1
    s_mov_b32 s81, 0x3ffff
    s_waitcnt lgkmcnt(0)
    s_mov_b64 exec, s[80:81]
    ds_read_b128 v[48:51], v13
    ds_read_b128 v[52:55], v13 offset:16
    s_mov_b64 exec, -1
    s_waitcnt lgkmcnt(0)
    v_max3_f32 v12, v48, v49, v50
    v_max3_f32 v12, v12, v51, v52
    v_max3_f32 v12, v12, v53, v54
    v_max_f32 v12, v12, v55
    s_nop 1
    v_max_f32_dpp v12, v12, v12 quad_perm:[1,0,3,2] row_mask:0xf bank_mask:0xf
    s_nop 1
    v_max_f32_dpp v12, v12, v12 quad_perm:[2,3,0,1] row_mask:0xf bank_mask:0xf
    s_nop 1
    v_max_f32_dpp v12, v12, v12 row_half_mirror row_mask:0xf bank_mask:0xf
    s_nop 1
    v_max_f32_dpp v12, v12, v12 row_mirror row_mask:0xf bank_mask:0xf
    v_mov_b32 v14, v12
    s_nop 1
    v_permlane16_swap_b32 v14, v12
    v_max_f32 v12, v14, v12
    v_mov_b32 v14, v12
    s_nop 1
    v_permlane32_swap_b32 v14, v12
    v_max_f32 v12, v14, v12
    v_mul_f32 v12, s66, v12
    v_fma_f32 v48, v48, s66, -v12
    v_fma_f32 v49, v49, s66, -v12
    v_fma_f32 v50, v50, s66, -v12
    v_fma_f32 v51, v51, s66, -v12
    v_fma_f32 v52, v52, s66, -v12
    v_fma_f32 v53, v53, s66, -v12
    v_fma_f32 v54, v54, s66, -v12
    v_fma_f32 v55, v55, s66, -v12
    v_exp_f32 v48, v48
    v_exp_f32 v49, v49
    v_exp_f32 v50, v50
    v_exp_f32 v51, v51
    v_exp_f32 v52, v52
    v_exp_f32 v53, v53
    v_exp_f32 v54, v54
    v_exp_f32 v55, v55
    s_nop 0
    v_add_f32 v11, v48, v49
    v_add_f32 v11, v11, v50
    v_add_f32 v11, v11, v51
    v_add_f32 v11, v11, v52
    v_add_f32 v11, v11, v53
    v_add_f32 v11, v11, v54
    v_add_f32 v11, v11, v55
    v_cvt_pk_bf16_f32 v48, v48, 0
    v_cvt_pk_bf16_f32 v49, v49, 0
    v_cvt_pk_bf16_f32 v50, v50, 0
    v_cvt_pk_bf16_f32 v51, v51, 0
    v_cvt_pk_bf16_f32 v52, v52, 0
    v_cvt_pk_bf16_f32 v53, v53, 0
    v_cvt_pk_bf16_f32 v54, v54, 0
    v_cvt_pk_bf16_f32 v55, v55, 0
    ds_write_b128 v13, v[48:51]
    ds_write_b128 v13, v[52:55] offset:16
    v_mov_b32 v32, 0
    v_mov_b32 v33, 0
    v_mov_b32 v34, 0
    v_mov_b32 v35, 0
    v_mov_b32 v36, 0
    v_mov_b32 v37, 0
    v_mov_b32 v38, 0
    v_mov_b32 v39, 0
    s_nop 1
    v_add_f32_dpp v11, v11, v11 quad_perm:[1,0,3,2] row_mask:0xf bank_mask:0xf
    s_nop 1
    v_add_f32_dpp v11, v11, v11 quad_perm:[2,3,0,1] row_mask:0xf bank_mask:0xf
    s_nop 1
    v_add_f32_dpp v11, v11, v11 row_half_mirror row_mask:0xf bank_mask:0xf
    s_nop 1
    v_add_f32_dpp v11, v11, v11 row_mirror row_mask:0xf bank_mask:0xf
    v_mov_b32 v14, v11
    s_nop 1
    v_permlane16_swap_b32 v14, v11
    v_add_f32 v11, v14, v11
    v_mov_b32 v14, v11
    s_nop 1
    v_permlane32_swap_b32 v14, v11
    v_add_f32 v11, v14, v11
    s_add_u32 s100, s70, s62
    s_cmp_lt_u32 s3, 2
    s_cselect_b64 vcc, -1, 0
    s_waitcnt lgkmcnt(0)
    s_mov_b32 s101, 128
    s_cmp_eq_u32 s62, 0
    s_cselect_b32 s101, 224, s101
    s_sub_u32 s64, 0x1000, s101
    ds_read_b128 v[16:19], v8 offset:576
    ds_read_b128 v[24:27], v8 offset:0
    s_waitcnt lgkmcnt(1)
    v_lshlrev_b32 v20, 16, v16
    v_lshlrev_b32 v21, 16, v17
    v_lshlrev_b32 v22, 16, v18
    v_lshlrev_b32 v23, 16, v19
    s_waitcnt vmcnt(8)
    ds_read_b128 v[48:51], v3 offset:0
    ds_read_b128 v[52:55], v3 offset:1024
    ds_read_b128 v[56:59], v3 offset:2048
    ds_read_b128 v[60:63], v3 offset:3072
    s_add_u32 s61, s60, 196608
    s_waitcnt vmcnt(11)
    v_dot2c_f32_bf16 v32, v64, v16
    v_dot2c_f32_bf16 v33, v64, v20
    v_dot2c_f32_bf16 v34, v65, v16
    v_dot2c_f32_bf16 v35, v65, v20
    v_dot2c_f32_bf16 v36, v66, v16
    v_dot2c_f32_bf16 v37, v66, v20
    v_dot2c_f32_bf16 v38, v67, v16
    v_dot2c_f32_bf16 v39, v67, v20
    buffer_load_dwordx4 v[64:67], v2, s[12:15], s61 offen offset:0
    s_waitcnt vmcnt(11)
    v_dot2c_f32_bf16 v32, v68, v17
    v_dot2c_f32_bf16 v33, v68, v21
    v_dot2c_f32_bf16 v34, v69, v17
    v_dot2c_f32_bf16 v35, v69, v21
    v_dot2c_f32_bf16 v36, v70, v17
    v_dot2c_f32_bf16 v37, v70, v21
    v_dot2c_f32_bf16 v38, v71, v17
    v_dot2c_f32_bf16 v39, v71, v21
    buffer_load_dwordx4 v[68:71], v2, s[12:15], s61 offen offset:256
    s_waitcnt vmcnt(11)
    v_dot2c_f32_bf16 v32, v72, v18
    v_dot2c_f32_bf16 v33, v72, v22
    v_dot2c_f32_bf16 v34, v73, v18
    v_dot2c_f32_bf16 v35, v73, v22
    v_dot2c_f32_bf16 v36, v74, v18
    v_dot2c_f32_bf16 v37, v74, v22
    v_dot2c_f32_bf16 v38, v75, v18
    v_dot2c_f32_bf16 v39, v75, v22
    buffer_load_dwordx4 v[72:75], v2, s[12:15], s61 offen offset:2048
    s_waitcnt vmcnt(11)
    v_dot2c_f32_bf16 v32, v76, v19
    v_dot2c_f32_bf16 v33, v76, v23
    v_dot2c_f32_bf16 v34, v77, v19
    v_dot2c_f32_bf16 v35, v77, v23
    v_dot2c_f32_bf16 v36, v78, v19
    v_dot2c_f32_bf16 v37, v78, v23
    v_dot2c_f32_bf16 v38, v79, v19
    v_dot2c_f32_bf16 v39, v79, v23
    buffer_load_dwordx4 v[76:79], v2, s[12:15], s61 offen offset:2304
    ds_read_b128 v[16:19], v8 offset:640
    s_waitcnt lgkmcnt(1)
    v_lshlrev_b32 v28, 16, v24
    v_lshlrev_b32 v29, 16, v25
    v_lshlrev_b32 v30, 16, v26
    v_lshlrev_b32 v31, 16, v27
    v_dot2c_f32_bf16 v32, v48, v24
    v_dot2c_f32_bf16 v33, v48, v28
    v_dot2c_f32_bf16 v34, v49, v24
    v_dot2c_f32_bf16 v35, v49, v28
    v_dot2c_f32_bf16 v36, v50, v24
    v_dot2c_f32_bf16 v37, v50, v28
    v_dot2c_f32_bf16 v38, v51, v24
    v_dot2c_f32_bf16 v39, v51, v28
    v_dot2c_f32_bf16 v32, v52, v25
    v_dot2c_f32_bf16 v33, v52, v29
    v_dot2c_f32_bf16 v34, v53, v25
    v_dot2c_f32_bf16 v35, v53, v29
    v_dot2c_f32_bf16 v36, v54, v25
    v_dot2c_f32_bf16 v37, v54, v29
    v_dot2c_f32_bf16 v38, v55, v25
    v_dot2c_f32_bf16 v39, v55, v29
    v_dot2c_f32_bf16 v32, v56, v26
    v_dot2c_f32_bf16 v33, v56, v30
    v_dot2c_f32_bf16 v34, v57, v26
    v_dot2c_f32_bf16 v35, v57, v30
    v_dot2c_f32_bf16 v36, v58, v26
    v_dot2c_f32_bf16 v37, v58, v30
    v_dot2c_f32_bf16 v38, v59, v26
    v_dot2c_f32_bf16 v39, v59, v30
    v_dot2c_f32_bf16 v32, v60, v27
    v_dot2c_f32_bf16 v33, v60, v31
    v_dot2c_f32_bf16 v34, v61, v27
    v_dot2c_f32_bf16 v35, v61, v31
    v_dot2c_f32_bf16 v36, v62, v27
    v_dot2c_f32_bf16 v37, v62, v31
    v_dot2c_f32_bf16 v38, v63, v27
    v_dot2c_f32_bf16 v39, v63, v31
    ds_read_b128 v[24:27], v8 offset:64
    s_waitcnt lgkmcnt(1)
    v_lshlrev_b32 v20, 16, v16
    v_lshlrev_b32 v21, 16, v17
    v_lshlrev_b32 v22, 16, v18
    v_lshlrev_b32 v23, 16, v19
    ds_read_b128 v[48:51], v3 offset:4096
    ds_read_b128 v[52:55], v3 offset:5120
    ds_read_b128 v[56:59], v3 offset:6144
    ds_read_b128 v[60:63], v3 offset:7168
    s_add_u32 s61, s60, 212992
    s_waitcnt vmcnt(11)
    v_dot2c_f32_bf16 v32, v80, v16
    v_dot2c_f32_bf16 v33, v80, v20
    v_dot2c_f32_bf16 v34, v81, v16
    v_dot2c_f32_bf16 v35, v81, v20
    v_dot2c_f32_bf16 v36, v82, v16
    v_dot2c_f32_bf16 v37, v82, v20
    v_dot2c_f32_bf16 v38, v83, v16
    v_dot2c_f32_bf16 v39, v83, v20
    buffer_load_dwordx4 v[80:83], v2, s[12:15], s61 offen offset:0
    s_waitcnt vmcnt(11)
    v_dot2c_f32_bf16 v32, v84, v17
    v_dot2c_f32_bf16 v33, v84, v21
    v_dot2c_f32_bf16 v34, v85, v17
    v_dot2c_f32_bf16 v35, v85, v21
    v_dot2c_f32_bf16 v36, v86, v17
    v_dot2c_f32_bf16 v37, v86, v21
    v_dot2c_f32_bf16 v38, v87, v17
    v_dot2c_f32_bf16 v39, v87, v21
    buffer_load_dwordx4 v[84:87], v2, s[12:15], s61 offen offset:256
    s_waitcnt vmcnt(11)
    v_dot2c_f32_bf16 v32, v88, v18
    v_dot2c_f32_bf16 v33, v88, v22
    v_dot2c_f32_bf16 v34, v89, v18
    v_dot2c_f32_bf16 v35, v89, v22
    v_dot2c_f32_bf16 v36, v90, v18
    v_dot2c_f32_bf16 v37, v90, v22
    v_dot2c_f32_bf16 v38, v91, v18
    v_dot2c_f32_bf16 v39, v91, v22
    buffer_load_dwordx4 v[88:91], v2, s[12:15], s61 offen offset:2048
    s_waitcnt vmcnt(11)
    v_dot2c_f32_bf16 v32, v92, v19
    v_dot2c_f32_bf16 v33, v92, v23
    v_dot2c_f32_bf16 v34, v93, v19
    v_dot2c_f32_bf16 v35, v93, v23
    v_dot2c_f32_bf16 v36, v94, v19
    v_dot2c_f32_bf16 v37, v94, v23
    v_dot2c_f32_bf16 v38, v95, v19
    v_dot2c_f32_bf16 v39, v95, v23
    buffer_load_dwordx4 v[92:95], v2, s[12:15], s61 offen offset:2304
    ds_read_b128 v[16:19], v8 offset:704
    s_waitcnt lgkmcnt(1)
    v_lshlrev_b32 v28, 16, v24
    v_lshlrev_b32 v29, 16, v25
    v_lshlrev_b32 v30, 16, v26
    v_lshlrev_b32 v31, 16, v27
    v_dot2c_f32_bf16 v32, v48, v24
    v_dot2c_f32_bf16 v33, v48, v28
    v_dot2c_f32_bf16 v34, v49, v24
    v_dot2c_f32_bf16 v35, v49, v28
    v_dot2c_f32_bf16 v36, v50, v24
    v_dot2c_f32_bf16 v37, v50, v28
    v_dot2c_f32_bf16 v38, v51, v24
    v_dot2c_f32_bf16 v39, v51, v28
    v_dot2c_f32_bf16 v32, v52, v25
    v_dot2c_f32_bf16 v33, v52, v29
    v_dot2c_f32_bf16 v34, v53, v25
    v_dot2c_f32_bf16 v35, v53, v29
    v_dot2c_f32_bf16 v36, v54, v25
    v_dot2c_f32_bf16 v37, v54, v29
    v_dot2c_f32_bf16 v38, v55, v25
    v_dot2c_f32_bf16 v39, v55, v29
    v_dot2c_f32_bf16 v32, v56, v26
    v_dot2c_f32_bf16 v33, v56, v30
    v_dot2c_f32_bf16 v34, v57, v26
    v_dot2c_f32_bf16 v35, v57, v30
    v_dot2c_f32_bf16 v36, v58, v26
    v_dot2c_f32_bf16 v37, v58, v30
    v_dot2c_f32_bf16 v38, v59, v26
    v_dot2c_f32_bf16 v39, v59, v30
    v_dot2c_f32_bf16 v32, v60, v27
    v_dot2c_f32_bf16 v33, v60, v31
    v_dot2c_f32_bf16 v34, v61, v27
    v_dot2c_f32_bf16 v35, v61, v31
    v_dot2c_f32_bf16 v36, v62, v27
    v_dot2c_f32_bf16 v37, v62, v31
    v_dot2c_f32_bf16 v38, v63, v27
    v_dot2c_f32_bf16 v39, v63, v31
    ds_read_b128 v[24:27], v8 offset:128
    s_waitcnt lgkmcnt(1)
    v_lshlrev_b32 v20, 16, v16
    v_lshlrev_b32 v21, 16, v17
    v_lshlrev_b32 v22, 16, v18
    v_lshlrev_b32 v23, 16, v19
    ds_read_b128 v[48:51], v3 offset:8192
    ds_read_b128 v[52:55], v3 offset:9216
    ds_read_b128 v[56:59], v3 offset:10240
    ds_read_b128 v[60:63], v3 offset:11264
    s_add_u32 s61, s60, 229376
    s_waitcnt vmcnt(11)
    v_dot2c_f32_bf16 v32, v96, v16
    v_dot2c_f32_bf16 v33, v96, v20
    v_dot2c_f32_bf16 v34, v97, v16
    v_dot2c_f32_bf16 v35, v97, v20
    v_dot2c_f32_bf16 v36, v98, v16
    v_dot2c_f32_bf16 v37, v98, v20
    v_dot2c_f32_bf16 v38, v99, v16
    v_dot2c_f32_bf16 v39, v99, v20
    buffer_load_dwordx4 v[96:99], v2, s[12:15], s61 offen offset:0
    s_waitcnt vmcnt(11)
    v_dot2c_f32_bf16 v32, v100, v17
    v_dot2c_f32_bf16 v33, v100, v21
    v_dot2c_f32_bf16 v34, v101, v17
    v_dot2c_f32_bf16 v35, v101, v21
    v_dot2c_f32_bf16 v36, v102, v17
    v_dot2c_f32_bf16 v37, v102, v21
    v_dot2c_f32_bf16 v38, v103, v17
    v_dot2c_f32_bf16 v39, v103, v21
    buffer_load_dwordx4 v[100:103], v2, s[12:15], s61 offen offset:256
    s_waitcnt vmcnt(11)
    v_dot2c_f32_bf16 v32, v104, v18
    v_dot2c_f32_bf16 v33, v104, v22
    v_dot2c_f32_bf16 v34, v105, v18
    v_dot2c_f32_bf16 v35, v105, v22
    v_dot2c_f32_bf16 v36, v106, v18
    v_dot2c_f32_bf16 v37, v106, v22
    v_dot2c_f32_bf16 v38, v107, v18
    v_dot2c_f32_bf16 v39, v107, v22
    buffer_load_dwordx4 v[104:107], v2, s[12:15], s61 offen offset:2048
    s_waitcnt vmcnt(11)
    v_dot2c_f32_bf16 v32, v108, v19
    v_dot2c_f32_bf16 v33, v108, v23
    v_dot2c_f32_bf16 v34, v109, v19
    v_dot2c_f32_bf16 v35, v109, v23
    v_dot2c_f32_bf16 v36, v110, v19
    v_dot2c_f32_bf16 v37, v110, v23
    v_dot2c_f32_bf16 v38, v111, v19
    v_dot2c_f32_bf16 v39, v111, v23
    buffer_load_dwordx4 v[108:111], v2, s[12:15], s61 offen offset:2304
    ds_read_b128 v[16:19], v8 offset:768
    s_waitcnt lgkmcnt(1)
    v_lshlrev_b32 v28, 16, v24
    v_lshlrev_b32 v29, 16, v25
    v_lshlrev_b32 v30, 16, v26
    v_lshlrev_b32 v31, 16, v27
    v_dot2c_f32_bf16 v32, v48, v24
    v_dot2c_f32_bf16 v33, v48, v28
    v_dot2c_f32_bf16 v34, v49, v24
    v_dot2c_f32_bf16 v35, v49, v28
    v_dot2c_f32_bf16 v36, v50, v24
    v_dot2c_f32_bf16 v37, v50, v28
    v_dot2c_f32_bf16 v38, v51, v24
    v_dot2c_f32_bf16 v39, v51, v28
    v_dot2c_f32_bf16 v32, v52, v25
    v_dot2c_f32_bf16 v33, v52, v29
    v_dot2c_f32_bf16 v34, v53, v25
    v_dot2c_f32_bf16 v35, v53, v29
    v_dot2c_f32_bf16 v36, v54, v25
    v_dot2c_f32_bf16 v37, v54, v29
    v_dot2c_f32_bf16 v38, v55, v25
    v_dot2c_f32_bf16 v39, v55, v29
    v_dot2c_f32_bf16 v32, v56, v26
    v_dot2c_f32_bf16 v33, v56, v30
    v_dot2c_f32_bf16 v34, v57, v26
    v_dot2c_f32_bf16 v35, v57, v30
    v_dot2c_f32_bf16 v36, v58, v26
    v_dot2c_f32_bf16 v37, v58, v30
    v_dot2c_f32_bf16 v38, v59, v26
    v_dot2c_f32_bf16 v39, v59, v30
    v_dot2c_f32_bf16 v32, v60, v27
    v_dot2c_f32_bf16 v33, v60, v31
    v_dot2c_f32_bf16 v34, v61, v27
    v_dot2c_f32_bf16 v35, v61, v31
    v_dot2c_f32_bf16 v36, v62, v27
    v_dot2c_f32_bf16 v37, v62, v31
    v_dot2c_f32_bf16 v38, v63, v27
    v_dot2c_f32_bf16 v39, v63, v31
    ds_read_b128 v[24:27], v8 offset:192
    s_waitcnt lgkmcnt(1)
    v_lshlrev_b32 v20, 16, v16
    v_lshlrev_b32 v21, 16, v17
    v_lshlrev_b32 v22, 16, v18
    v_lshlrev_b32 v23, 16, v19
    ds_read_b128 v[48:51], v3 offset:12288
    ds_read_b128 v[52:55], v3 offset:13312
    ds_read_b128 v[56:59], v3 offset:14336
    ds_read_b128 v[60:63], v3 offset:15360
    s_add_u32 s61, s60, 245760
    s_waitcnt vmcnt(11)
    v_dot2c_f32_bf16 v32, v64, v16
    v_dot2c_f32_bf16 v33, v64, v20
    v_dot2c_f32_bf16 v34, v65, v16
    v_dot2c_f32_bf16 v35, v65, v20
    v_dot2c_f32_bf16 v36, v66, v16
    v_dot2c_f32_bf16 v37, v66, v20
    v_dot2c_f32_bf16 v38, v67, v16
    v_dot2c_f32_bf16 v39, v67, v20
    buffer_load_dwordx4 v[64:67], v2, s[12:15], s61 offen offset:0
    s_waitcnt vmcnt(11)
    v_dot2c_f32_bf16 v32, v68, v17
    v_dot2c_f32_bf16 v33, v68, v21
    v_dot2c_f32_bf16 v34, v69, v17
    v_dot2c_f32_bf16 v35, v69, v21
    v_dot2c_f32_bf16 v36, v70, v17
    v_dot2c_f32_bf16 v37, v70, v21
    v_dot2c_f32_bf16 v38, v71, v17
    v_dot2c_f32_bf16 v39, v71, v21
    buffer_load_dwordx4 v[68:71], v2, s[12:15], s61 offen offset:256
    s_waitcnt vmcnt(11)
    v_dot2c_f32_bf16 v32, v72, v18
    v_dot2c_f32_bf16 v33, v72, v22
    v_dot2c_f32_bf16 v34, v73, v18
    v_dot2c_f32_bf16 v35, v73, v22
    v_dot2c_f32_bf16 v36, v74, v18
    v_dot2c_f32_bf16 v37, v74, v22
    v_dot2c_f32_bf16 v38, v75, v18
    v_dot2c_f32_bf16 v39, v75, v22
    buffer_load_dwordx4 v[72:75], v2, s[12:15], s61 offen offset:2048
    s_waitcnt vmcnt(11)
    v_dot2c_f32_bf16 v32, v76, v19
    v_dot2c_f32_bf16 v33, v76, v23
    v_dot2c_f32_bf16 v34, v77, v19
    v_dot2c_f32_bf16 v35, v77, v23
    v_dot2c_f32_bf16 v36, v78, v19
    v_dot2c_f32_bf16 v37, v78, v23
    v_dot2c_f32_bf16 v38, v79, v19
    v_dot2c_f32_bf16 v39, v79, v23
    buffer_load_dwordx4 v[76:79], v2, s[12:15], s61 offen offset:2304
    ds_read_b128 v[16:19], v8 offset:832
    s_waitcnt lgkmcnt(1)
    v_lshlrev_b32 v28, 16, v24
    v_lshlrev_b32 v29, 16, v25
    v_lshlrev_b32 v30, 16, v26
    v_lshlrev_b32 v31, 16, v27
    v_dot2c_f32_bf16 v32, v48, v24
    v_dot2c_f32_bf16 v33, v48, v28
    v_dot2c_f32_bf16 v34, v49, v24
    v_dot2c_f32_bf16 v35, v49, v28
    v_dot2c_f32_bf16 v36, v50, v24
    v_dot2c_f32_bf16 v37, v50, v28
    v_dot2c_f32_bf16 v38, v51, v24
    v_dot2c_f32_bf16 v39, v51, v28
    v_dot2c_f32_bf16 v32, v52, v25
    v_dot2c_f32_bf16 v33, v52, v29
    v_dot2c_f32_bf16 v34, v53, v25
    v_dot2c_f32_bf16 v35, v53, v29
    v_dot2c_f32_bf16 v36, v54, v25
    v_dot2c_f32_bf16 v37, v54, v29
    v_dot2c_f32_bf16 v38, v55, v25
    v_dot2c_f32_bf16 v39, v55, v29
    v_dot2c_f32_bf16 v32, v56, v26
    v_dot2c_f32_bf16 v33, v56, v30
    v_dot2c_f32_bf16 v34, v57, v26
    v_dot2c_f32_bf16 v35, v57, v30
    v_dot2c_f32_bf16 v36, v58, v26
    v_dot2c_f32_bf16 v37, v58, v30
    v_dot2c_f32_bf16 v38, v59, v26
    v_dot2c_f32_bf16 v39, v59, v30
    v_dot2c_f32_bf16 v32, v60, v27
    v_dot2c_f32_bf16 v33, v60, v31
    v_dot2c_f32_bf16 v34, v61, v27
    v_dot2c_f32_bf16 v35, v61, v31
    v_dot2c_f32_bf16 v36, v62, v27
    v_dot2c_f32_bf16 v37, v62, v31
    v_dot2c_f32_bf16 v38, v63, v27
    v_dot2c_f32_bf16 v39, v63, v31
    ds_read_b128 v[24:27], v8 offset:256
    s_waitcnt lgkmcnt(1)
    v_lshlrev_b32 v20, 16, v16
    v_lshlrev_b32 v21, 16, v17
    v_lshlrev_b32 v22, 16, v18
    v_lshlrev_b32 v23, 16, v19
    ds_read_b128 v[48:51], v3 offset:16384
    ds_read_b128 v[52:55], v3 offset:17408
    ds_read_b128 v[56:59], v3 offset:18432
    ds_read_b128 v[60:63], v3 offset:19456
    s_add_u32 s61, s60, 262144
    s_waitcnt vmcnt(11)
    v_dot2c_f32_bf16 v32, v80, v16
    v_dot2c_f32_bf16 v33, v80, v20
    v_dot2c_f32_bf16 v34, v81, v16
    v_dot2c_f32_bf16 v35, v81, v20
    v_dot2c_f32_bf16 v36, v82, v16
    v_dot2c_f32_bf16 v37, v82, v20
    v_dot2c_f32_bf16 v38, v83, v16
    v_dot2c_f32_bf16 v39, v83, v20
    buffer_load_dwordx4 v[80:83], v2, s[12:15], s61 offen offset:0 nt
    s_waitcnt vmcnt(11)
    v_dot2c_f32_bf16 v32, v84, v17
    v_dot2c_f32_bf16 v33, v84, v21
    v_dot2c_f32_bf16 v34, v85, v17
    v_dot2c_f32_bf16 v35, v85, v21
    v_dot2c_f32_bf16 v36, v86, v17
    v_dot2c_f32_bf16 v37, v86, v21
    v_dot2c_f32_bf16 v38, v87, v17
    v_dot2c_f32_bf16 v39, v87, v21
    buffer_load_dwordx4 v[84:87], v2, s[12:15], s61 offen offset:256 nt
    s_waitcnt vmcnt(11)
    v_dot2c_f32_bf16 v32, v88, v18
    v_dot2c_f32_bf16 v33, v88, v22
    v_dot2c_f32_bf16 v34, v89, v18
    v_dot2c_f32_bf16 v35, v89, v22
    v_dot2c_f32_bf16 v36, v90, v18
    v_dot2c_f32_bf16 v37, v90, v22
    v_dot2c_f32_bf16 v38, v91, v18
    v_dot2c_f32_bf16 v39, v91, v22
    buffer_load_dwordx4 v[88:91], v2, s[12:15], s61 offen offset:2048 nt
    s_waitcnt vmcnt(11)
    v_dot2c_f32_bf16 v32, v92, v19
    v_dot2c_f32_bf16 v33, v92, v23
    v_dot2c_f32_bf16 v34, v93, v19
    v_dot2c_f32_bf16 v35, v93, v23
    v_dot2c_f32_bf16 v36, v94, v19
    v_dot2c_f32_bf16 v37, v94, v23
    v_dot2c_f32_bf16 v38, v95, v19
    v_dot2c_f32_bf16 v39, v95, v23
    buffer_load_dwordx4 v[92:95], v2, s[12:15], s61 offen offset:2304 nt
    ds_read_b128 v[16:19], v8 offset:896
    s_waitcnt lgkmcnt(1)
    v_lshlrev_b32 v28, 16, v24
    v_lshlrev_b32 v29, 16, v25
    v_lshlrev_b32 v30, 16, v26
    v_lshlrev_b32 v31, 16, v27
    v_dot2c_f32_bf16 v32, v48, v24
    v_dot2c_f32_bf16 v33, v48, v28
    v_dot2c_f32_bf16 v34, v49, v24
    v_dot2c_f32_bf16 v35, v49, v28
    v_dot2c_f32_bf16 v36, v50, v24
    v_dot2c_f32_bf16 v37, v50, v28
    v_dot2c_f32_bf16 v38, v51, v24
    v_dot2c_f32_bf16 v39, v51, v28
    v_dot2c_f32_bf16 v32, v52, v25
    v_dot2c_f32_bf16 v33, v52, v29
    v_dot2c_f32_bf16 v34, v53, v25
    v_dot2c_f32_bf16 v35, v53, v29
    v_dot2c_f32_bf16 v36, v54, v25
    v_dot2c_f32_bf16 v37, v54, v29
    v_dot2c_f32_bf16 v38, v55, v25
    v_dot2c_f32_bf16 v39, v55, v29
    v_dot2c_f32_bf16 v32, v56, v26
    v_dot2c_f32_bf16 v33, v56, v30
    v_dot2c_f32_bf16 v34, v57, v26
    v_dot2c_f32_bf16 v35, v57, v30
    v_dot2c_f32_bf16 v36, v58, v26
    v_dot2c_f32_bf16 v37, v58, v30
    v_dot2c_f32_bf16 v38, v59, v26
    v_dot2c_f32_bf16 v39, v59, v30
    v_dot2c_f32_bf16 v32, v60, v27
    v_dot2c_f32_bf16 v33, v60, v31
    v_dot2c_f32_bf16 v34, v61, v27
    v_dot2c_f32_bf16 v35, v61, v31
    v_dot2c_f32_bf16 v36, v62, v27
    v_dot2c_f32_bf16 v37, v62, v31
    v_dot2c_f32_bf16 v38, v63, v27
    v_dot2c_f32_bf16 v39, v63, v31
    ds_read_b128 v[24:27], v8 offset:320
    s_waitcnt lgkmcnt(1)
    v_lshlrev_b32 v20, 16, v16
    v_lshlrev_b32 v21, 16, v17
    v_lshlrev_b32 v22, 16, v18
    v_lshlrev_b32 v23, 16, v19
    ds_read_b128 v[48:51], v3 offset:20480
    ds_read_b128 v[52:55], v3 offset:21504
    ds_read_b128 v[56:59], v3 offset:22528
    ds_read_b128 v[60:63], v3 offset:23552
    s_add_u32 s61, s60, 278528
    s_waitcnt vmcnt(11)
    v_dot2c_f32_bf16 v32, v96, v16
    v_dot2c_f32_bf16 v33, v96, v20
    v_dot2c_f32_bf16 v34, v97, v16
    v_dot2c_f32_bf16 v35, v97, v20
    v_dot2c_f32_bf16 v36, v98, v16
    v_dot2c_f32_bf16 v37, v98, v20
    v_dot2c_f32_bf16 v38, v99, v16
    v_dot2c_f32_bf16 v39, v99, v20
    buffer_load_dwordx4 v[96:99], v2, s[12:15], s61 offen offset:0 nt
    s_waitcnt vmcnt(11)
    v_dot2c_f32_bf16 v32, v100, v17
    v_dot2c_f32_bf16 v33, v100, v21
    v_dot2c_f32_bf16 v34, v101, v17
    v_dot2c_f32_bf16 v35, v101, v21
    v_dot2c_f32_bf16 v36, v102, v17
    v_dot2c_f32_bf16 v37, v102, v21
    v_dot2c_f32_bf16 v38, v103, v17
    v_dot2c_f32_bf16 v39, v103, v21
    buffer_load_dwordx4 v[100:103], v2, s[12:15], s61 offen offset:256 nt
    s_waitcnt vmcnt(11)
    v_dot2c_f32_bf16 v32, v104, v18
    v_dot2c_f32_bf16 v33, v104, v22
    v_dot2c_f32_bf16 v34, v105, v18
    v_dot2c_f32_bf16 v35, v105, v22
    v_dot2c_f32_bf16 v36, v106, v18
    v_dot2c_f32_bf16 v37, v106, v22
    v_dot2c_f32_bf16 v38, v107, v18
    v_dot2c_f32_bf16 v39, v107, v22
    buffer_load_dwordx4 v[104:107], v2, s[12:15], s61 offen offset:2048 nt
    s_waitcnt vmcnt(11)
    v_dot2c_f32_bf16 v32, v108, v19
    v_dot2c_f32_bf16 v33, v108, v23
    v_dot2c_f32_bf16 v34, v109, v19
    v_dot2c_f32_bf16 v35, v109, v23
    v_dot2c_f32_bf16 v36, v110, v19
    v_dot2c_f32_bf16 v37, v110, v23
    v_dot2c_f32_bf16 v38, v111, v19
    v_dot2c_f32_bf16 v39, v111, v23
    buffer_load_dwordx4 v[108:111], v2, s[12:15], s61 offen offset:2304 nt
    ds_read_b128 v[16:19], v8 offset:960
    s_waitcnt lgkmcnt(1)
    v_lshlrev_b32 v28, 16, v24
    v_lshlrev_b32 v29, 16, v25
    v_lshlrev_b32 v30, 16, v26
    v_lshlrev_b32 v31, 16, v27
    v_dot2c_f32_bf16 v32, v48, v24
    v_dot2c_f32_bf16 v33, v48, v28
    v_dot2c_f32_bf16 v34, v49, v24
    v_dot2c_f32_bf16 v35, v49, v28
    v_dot2c_f32_bf16 v36, v50, v24
    v_dot2c_f32_bf16 v37, v50, v28
    v_dot2c_f32_bf16 v38, v51, v24
    v_dot2c_f32_bf16 v39, v51, v28
    v_dot2c_f32_bf16 v32, v52, v25
    v_dot2c_f32_bf16 v33, v52, v29
    v_dot2c_f32_bf16 v34, v53, v25
    v_dot2c_f32_bf16 v35, v53, v29
    v_dot2c_f32_bf16 v36, v54, v25
    v_dot2c_f32_bf16 v37, v54, v29
    v_dot2c_f32_bf16 v38, v55, v25
    v_dot2c_f32_bf16 v39, v55, v29
    v_dot2c_f32_bf16 v32, v56, v26
    v_dot2c_f32_bf16 v33, v56, v30
    v_dot2c_f32_bf16 v34, v57, v26
    v_dot2c_f32_bf16 v35, v57, v30
    v_dot2c_f32_bf16 v36, v58, v26
    v_dot2c_f32_bf16 v37, v58, v30
    v_dot2c_f32_bf16 v38, v59, v26
    v_dot2c_f32_bf16 v39, v59, v30
    v_dot2c_f32_bf16 v32, v60, v27
    v_dot2c_f32_bf16 v33, v60, v31
    v_dot2c_f32_bf16 v34, v61, v27
    v_dot2c_f32_bf16 v35, v61, v31
    v_dot2c_f32_bf16 v36, v62, v27
    v_dot2c_f32_bf16 v37, v62, v31
    v_dot2c_f32_bf16 v38, v63, v27
    v_dot2c_f32_bf16 v39, v63, v31
    ds_read_b128 v[24:27], v8 offset:384
    s_waitcnt lgkmcnt(1)
    v_lshlrev_b32 v20, 16, v16
    v_lshlrev_b32 v21, 16, v17
    v_lshlrev_b32 v22, 16, v18
    v_lshlrev_b32 v23, 16, v19
    ds_read_b128 v[48:51], v3 offset:24576
    ds_read_b128 v[52:55], v3 offset:25600
    ds_read_b128 v[56:59], v3 offset:26624
    ds_read_b128 v[60:63], v3 offset:27648
    s_add_u32 s61, s60, 294912
    s_waitcnt vmcnt(11)
    v_dot2c_f32_bf16 v32, v64, v16
    v_dot2c_f32_bf16 v33, v64, v20
    v_dot2c_f32_bf16 v34, v65, v16
    v_dot2c_f32_bf16 v35, v65, v20
    v_dot2c_f32_bf16 v36, v66, v16
    v_dot2c_f32_bf16 v37, v66, v20
    v_dot2c_f32_bf16 v38, v67, v16
    v_dot2c_f32_bf16 v39, v67, v20
    buffer_load_dwordx4 v[64:67], v2, s[12:15], s61 offen offset:0 nt
    s_waitcnt vmcnt(11)
    v_dot2c_f32_bf16 v32, v68, v17
    v_dot2c_f32_bf16 v33, v68, v21
    v_dot2c_f32_bf16 v34, v69, v17
    v_dot2c_f32_bf16 v35, v69, v21
    v_dot2c_f32_bf16 v36, v70, v17
    v_dot2c_f32_bf16 v37, v70, v21
    v_dot2c_f32_bf16 v38, v71, v17
    v_dot2c_f32_bf16 v39, v71, v21
    buffer_load_dwordx4 v[68:71], v2, s[12:15], s61 offen offset:256 nt
    s_waitcnt vmcnt(11)
    v_dot2c_f32_bf16 v32, v72, v18
    v_dot2c_f32_bf16 v33, v72, v22
    v_dot2c_f32_bf16 v34, v73, v18
    v_dot2c_f32_bf16 v35, v73, v22
    v_dot2c_f32_bf16 v36, v74, v18
    v_dot2c_f32_bf16 v37, v74, v22
    v_dot2c_f32_bf16 v38, v75, v18
    v_dot2c_f32_bf16 v39, v75, v22
    buffer_load_dwordx4 v[72:75], v2, s[12:15], s61 offen offset:2048 nt
    s_waitcnt vmcnt(11)
    v_dot2c_f32_bf16 v32, v76, v19
    v_dot2c_f32_bf16 v33, v76, v23
    v_dot2c_f32_bf16 v34, v77, v19
    v_dot2c_f32_bf16 v35, v77, v23
    v_dot2c_f32_bf16 v36, v78, v19
    v_dot2c_f32_bf16 v37, v78, v23
    v_dot2c_f32_bf16 v38, v79, v19
    v_dot2c_f32_bf16 v39, v79, v23
    buffer_load_dwordx4 v[76:79], v2, s[12:15], s61 offen offset:2304 nt
    ds_read_b128 v[16:19], v8 offset:1024
    s_waitcnt lgkmcnt(1)
    v_lshlrev_b32 v28, 16, v24
    v_lshlrev_b32 v29, 16, v25
    v_lshlrev_b32 v30, 16, v26
    v_lshlrev_b32 v31, 16, v27
    v_dot2c_f32_bf16 v32, v48, v24
    v_dot2c_f32_bf16 v33, v48, v28
    v_dot2c_f32_bf16 v34, v49, v24
    v_dot2c_f32_bf16 v35, v49, v28
    v_dot2c_f32_bf16 v36, v50, v24
    v_dot2c_f32_bf16 v37, v50, v28
    v_dot2c_f32_bf16 v38, v51, v24
    v_dot2c_f32_bf16 v39, v51, v28
    v_dot2c_f32_bf16 v32, v52, v25
    v_dot2c_f32_bf16 v33, v52, v29
    v_dot2c_f32_bf16 v34, v53, v25
    v_dot2c_f32_bf16 v35, v53, v29
    v_dot2c_f32_bf16 v36, v54, v25
    v_dot2c_f32_bf16 v37, v54, v29
    v_dot2c_f32_bf16 v38, v55, v25
    v_dot2c_f32_bf16 v39, v55, v29
    v_dot2c_f32_bf16 v32, v56, v26
    v_dot2c_f32_bf16 v33, v56, v30
    v_dot2c_f32_bf16 v34, v57, v26
    v_dot2c_f32_bf16 v35, v57, v30
    v_dot2c_f32_bf16 v36, v58, v26
    v_dot2c_f32_bf16 v37, v58, v30
    v_dot2c_f32_bf16 v38, v59, v26
    v_dot2c_f32_bf16 v39, v59, v30
    v_dot2c_f32_bf16 v32, v60, v27
    v_dot2c_f32_bf16 v33, v60, v31
    v_dot2c_f32_bf16 v34, v61, v27
    v_dot2c_f32_bf16 v35, v61, v31
    v_dot2c_f32_bf16 v36, v62, v27
    v_dot2c_f32_bf16 v37, v62, v31
    v_dot2c_f32_bf16 v38, v63, v27
    v_dot2c_f32_bf16 v39, v63, v31
    ds_read_b128 v[24:27], v8 offset:448
    s_waitcnt lgkmcnt(1)
    v_lshlrev_b32 v20, 16, v16
    v_lshlrev_b32 v21, 16, v17
    v_lshlrev_b32 v22, 16, v18
    v_lshlrev_b32 v23, 16, v19
    ds_read_b128 v[48:51], v3 offset:28672
    ds_read_b128 v[52:55], v3 offset:29696
    ds_read_b128 v[56:59], v3 offset:30720
    ds_read_b128 v[60:63], v3 offset:31744
    s_add_u32 s61, s60, 311296
    s_waitcnt vmcnt(11)
    v_dot2c_f32_bf16 v32, v80, v16
    v_dot2c_f32_bf16 v33, v80, v20
    v_dot2c_f32_bf16 v34, v81, v16
    v_dot2c_f32_bf16 v35, v81, v20
    v_dot2c_f32_bf16 v36, v82, v16
    v_dot2c_f32_bf16 v37, v82, v20
    v_dot2c_f32_bf16 v38, v83, v16
    v_dot2c_f32_bf16 v39, v83, v20
    buffer_load_dwordx4 v[80:83], v2, s[12:15], s61 offen offset:0 nt
    s_waitcnt vmcnt(11)
    v_dot2c_f32_bf16 v32, v84, v17
    v_dot2c_f32_bf16 v33, v84, v21
    v_dot2c_f32_bf16 v34, v85, v17
    v_dot2c_f32_bf16 v35, v85, v21
    v_dot2c_f32_bf16 v36, v86, v17
    v_dot2c_f32_bf16 v37, v86, v21
    v_dot2c_f32_bf16 v38, v87, v17
    v_dot2c_f32_bf16 v39, v87, v21
    buffer_load_dwordx4 v[84:87], v2, s[12:15], s61 offen offset:256 nt
    s_waitcnt vmcnt(11)
    v_dot2c_f32_bf16 v32, v88, v18
    v_dot2c_f32_bf16 v33, v88, v22
    v_dot2c_f32_bf16 v34, v89, v18
    v_dot2c_f32_bf16 v35, v89, v22
    v_dot2c_f32_bf16 v36, v90, v18
    v_dot2c_f32_bf16 v37, v90, v22
    v_dot2c_f32_bf16 v38, v91, v18
    v_dot2c_f32_bf16 v39, v91, v22
    buffer_load_dwordx4 v[88:91], v2, s[12:15], s61 offen offset:2048 nt
    s_waitcnt vmcnt(11)
    v_dot2c_f32_bf16 v32, v92, v19
    v_dot2c_f32_bf16 v33, v92, v23
    v_dot2c_f32_bf16 v34, v93, v19
    v_dot2c_f32_bf16 v35, v93, v23
    v_dot2c_f32_bf16 v36, v94, v19
    v_dot2c_f32_bf16 v37, v94, v23
    v_dot2c_f32_bf16 v38, v95, v19
    v_dot2c_f32_bf16 v39, v95, v23
    buffer_load_dwordx4 v[92:95], v2, s[12:15], s61 offen offset:2304 nt
    ds_read_b128 v[16:19], v8 offset:1088
    s_waitcnt lgkmcnt(1)
    v_lshlrev_b32 v28, 16, v24
    v_lshlrev_b32 v29, 16, v25
    v_lshlrev_b32 v30, 16, v26
    v_lshlrev_b32 v31, 16, v27
    v_dot2c_f32_bf16 v32, v48, v24
    v_dot2c_f32_bf16 v33, v48, v28
    v_dot2c_f32_bf16 v34, v49, v24
    v_dot2c_f32_bf16 v35, v49, v28
    v_dot2c_f32_bf16 v36, v50, v24
    v_dot2c_f32_bf16 v37, v50, v28
    v_dot2c_f32_bf16 v38, v51, v24
    v_dot2c_f32_bf16 v39, v51, v28
    v_dot2c_f32_bf16 v32, v52, v25
    v_dot2c_f32_bf16 v33, v52, v29
    v_dot2c_f32_bf16 v34, v53, v25
    v_dot2c_f32_bf16 v35, v53, v29
    v_dot2c_f32_bf16 v36, v54, v25
    v_dot2c_f32_bf16 v37, v54, v29
    v_dot2c_f32_bf16 v38, v55, v25
    v_dot2c_f32_bf16 v39, v55, v29
    v_dot2c_f32_bf16 v32, v56, v26
    v_dot2c_f32_bf16 v33, v56, v30
    v_dot2c_f32_bf16 v34, v57, v26
    v_dot2c_f32_bf16 v35, v57, v30
    v_dot2c_f32_bf16 v36, v58, v26
    v_dot2c_f32_bf16 v37, v58, v30
    v_dot2c_f32_bf16 v38, v59, v26
    v_dot2c_f32_bf16 v39, v59, v30
    v_dot2c_f32_bf16 v32, v60, v27
    v_dot2c_f32_bf16 v33, v60, v31
    v_dot2c_f32_bf16 v34, v61, v27
    v_dot2c_f32_bf16 v35, v61, v31
    v_dot2c_f32_bf16 v36, v62, v27
    v_dot2c_f32_bf16 v37, v62, v31
    v_dot2c_f32_bf16 v38, v63, v27
    v_dot2c_f32_bf16 v39, v63, v31
    ds_read_b128 v[24:27], v8 offset:512
    s_waitcnt lgkmcnt(1)
    v_lshlrev_b32 v20, 16, v16
    v_lshlrev_b32 v21, 16, v17
    v_lshlrev_b32 v22, 16, v18
    v_lshlrev_b32 v23, 16, v19
    ds_read_b128 v[48:51], v3 offset:32768
    ds_read_b128 v[52:55], v3 offset:33792
    ds_read_b128 v[56:59], v3 offset:34816
    ds_read_b128 v[60:63], v3 offset:35840
    s_add_u32 s61, s60, 327680
    s_waitcnt vmcnt(11)
    v_dot2c_f32_bf16 v32, v96, v16
    v_dot2c_f32_bf16 v33, v96, v20
    v_dot2c_f32_bf16 v34, v97, v16
    v_dot2c_f32_bf16 v35, v97, v20
    v_dot2c_f32_bf16 v36, v98, v16
    v_dot2c_f32_bf16 v37, v98, v20
    v_dot2c_f32_bf16 v38, v99, v16
    v_dot2c_f32_bf16 v39, v99, v20
    buffer_load_dwordx4 v[96:99], v2, s[12:15], s61 offen offset:0 nt
    s_waitcnt vmcnt(11)
    v_dot2c_f32_bf16 v32, v100, v17
    v_dot2c_f32_bf16 v33, v100, v21
    v_dot2c_f32_bf16 v34, v101, v17
    v_dot2c_f32_bf16 v35, v101, v21
    v_dot2c_f32_bf16 v36, v102, v17
    v_dot2c_f32_bf16 v37, v102, v21
    v_dot2c_f32_bf16 v38, v103, v17
    v_dot2c_f32_bf16 v39, v103, v21
    buffer_load_dwordx4 v[100:103], v2, s[12:15], s61 offen offset:256 nt
    s_waitcnt vmcnt(11)
    v_dot2c_f32_bf16 v32, v104, v18
    v_dot2c_f32_bf16 v33, v104, v22
    v_dot2c_f32_bf16 v34, v105, v18
    v_dot2c_f32_bf16 v35, v105, v22
    v_dot2c_f32_bf16 v36, v106, v18
    v_dot2c_f32_bf16 v37, v106, v22
    v_dot2c_f32_bf16 v38, v107, v18
    v_dot2c_f32_bf16 v39, v107, v22
    buffer_load_dwordx4 v[104:107], v2, s[12:15], s61 offen offset:2048 nt
    s_waitcnt vmcnt(11)
    v_dot2c_f32_bf16 v32, v108, v19
    v_dot2c_f32_bf16 v33, v108, v23
    v_dot2c_f32_bf16 v34, v109, v19
    v_dot2c_f32_bf16 v35, v109, v23
    v_dot2c_f32_bf16 v36, v110, v19
    v_dot2c_f32_bf16 v37, v110, v23
    v_dot2c_f32_bf16 v38, v111, v19
    v_dot2c_f32_bf16 v39, v111, v23
    buffer_load_dwordx4 v[108:111], v2, s[12:15], s61 offen offset:2304 nt
    ds_read_b128 v[16:19], v8 offset:1152
    s_waitcnt lgkmcnt(1)
    v_lshlrev_b32 v28, 16, v24
    v_lshlrev_b32 v29, 16, v25
    v_lshlrev_b32 v30, 16, v26
    v_lshlrev_b32 v31, 16, v27
    v_dot2c_f32_bf16 v32, v48, v24
    v_dot2c_f32_bf16 v33, v48, v28
    v_dot2c_f32_bf16 v34, v49, v24
    v_dot2c_f32_bf16 v35, v49, v28
    v_dot2c_f32_bf16 v36, v50, v24
    v_dot2c_f32_bf16 v37, v50, v28
    v_dot2c_f32_bf16 v38, v51, v24
    v_dot2c_f32_bf16 v39, v51, v28
    v_dot2c_f32_bf16 v32, v52, v25
    v_dot2c_f32_bf16 v33, v52, v29
    v_dot2c_f32_bf16 v34, v53, v25
    v_dot2c_f32_bf16 v35, v53, v29
    v_dot2c_f32_bf16 v36, v54, v25
    v_dot2c_f32_bf16 v37, v54, v29
    v_dot2c_f32_bf16 v38, v55, v25
    v_dot2c_f32_bf16 v39, v55, v29
    v_dot2c_f32_bf16 v32, v56, v26
    v_dot2c_f32_bf16 v33, v56, v30
    v_dot2c_f32_bf16 v34, v57, v26
    v_dot2c_f32_bf16 v35, v57, v30
    v_dot2c_f32_bf16 v36, v58, v26
    v_dot2c_f32_bf16 v37, v58, v30
    v_dot2c_f32_bf16 v38, v59, v26
    v_dot2c_f32_bf16 v39, v59, v30
    v_dot2c_f32_bf16 v32, v60, v27
    v_dot2c_f32_bf16 v33, v60, v31
    v_dot2c_f32_bf16 v34, v61, v27
    v_dot2c_f32_bf16 v35, v61, v31
    v_dot2c_f32_bf16 v36, v62, v27
    v_dot2c_f32_bf16 v37, v62, v31
    v_dot2c_f32_bf16 v38, v63, v27
    v_dot2c_f32_bf16 v39, v63, v31
    ds_read_b128 v[24:27], v8 offset:1216
    s_waitcnt lgkmcnt(1)
    v_lshlrev_b32 v20, 16, v16
    v_lshlrev_b32 v21, 16, v17
    v_lshlrev_b32 v22, 16, v18
    v_lshlrev_b32 v23, 16, v19
    s_add_u32 s61, s60, 344064
    s_cmp_eq_u32 s62, 0
    s_cbranch_scc1 L_9
    s_lshl_b32 s68, s5, 2
    s_add_u32 s68, s68, s3
    s_mul_i32 s68, s68, 3
    s_add_u32 s68, s68, 4223
    v_mov_b32 v60, s68
    s_branch L_10
L_9:
    v_mov_b32 v60, 1
    s_mov_b64 exec, 1
    buffer_atomic_add v60, off, s[16:19], s100 offset:3840 sc0 sc1
    s_mov_b64 exec, -1
L_10:
    s_cmp_eq_u32 s62, 0
    s_cbranch_scc1 L_11
    s_lshl_b32 s68, s5, 2
    s_add_u32 s68, s68, s3
    s_mul_i32 s68, s68, 3
    s_add_u32 s68, s68, 4224
    v_mov_b32 v61, s68
    s_branch L_12
L_11:
    v_mov_b32 v61, 1
    s_mov_b64 exec, 1
    buffer_atomic_add v61, off, s[16:19], s100 offset:3840 sc0 sc1
    s_mov_b64 exec, -1
L_12:
    s_waitcnt vmcnt(11)
    v_dot2c_f32_bf16 v32, v64, v16
    v_dot2c_f32_bf16 v33, v64, v20
    v_dot2c_f32_bf16 v34, v65, v16
    v_dot2c_f32_bf16 v35, v65, v20
    v_dot2c_f32_bf16 v36, v66, v16
    v_dot2c_f32_bf16 v37, v66, v20
    v_dot2c_f32_bf16 v38, v67, v16
    v_dot2c_f32_bf16 v39, v67, v20
    buffer_load_dwordx4 v[64:67], v2, s[12:15], s61 offen offset:0 nt
    s_waitcnt vmcnt(11)
    v_dot2c_f32_bf16 v32, v68, v17
    v_dot2c_f32_bf16 v33, v68, v21
    v_dot2c_f32_bf16 v34, v69, v17
    v_dot2c_f32_bf16 v35, v69, v21
    v_dot2c_f32_bf16 v36, v70, v17
    v_dot2c_f32_bf16 v37, v70, v21
    v_dot2c_f32_bf16 v38, v71, v17
    v_dot2c_f32_bf16 v39, v71, v21
    buffer_load_dwordx4 v[68:71], v2, s[12:15], s61 offen offset:256 nt
    s_waitcnt vmcnt(11)
    v_dot2c_f32_bf16 v32, v72, v18
    v_dot2c_f32_bf16 v33, v72, v22
    v_dot2c_f32_bf16 v34, v73, v18
    v_dot2c_f32_bf16 v35, v73, v22
    v_dot2c_f32_bf16 v36, v74, v18
    v_dot2c_f32_bf16 v37, v74, v22
    v_dot2c_f32_bf16 v38, v75, v18
    v_dot2c_f32_bf16 v39, v75, v22
    buffer_load_dwordx4 v[72:75], v2, s[12:15], s61 offen offset:2048 nt
    s_waitcnt vmcnt(11)
    v_dot2c_f32_bf16 v32, v76, v19
    v_dot2c_f32_bf16 v33, v76, v23
    v_dot2c_f32_bf16 v34, v77, v19
    v_dot2c_f32_bf16 v35, v77, v23
    v_dot2c_f32_bf16 v36, v78, v19
    v_dot2c_f32_bf16 v37, v78, v23
    v_dot2c_f32_bf16 v38, v79, v19
    v_dot2c_f32_bf16 v39, v79, v23
    buffer_load_dwordx4 v[76:79], v2, s[12:15], s61 offen offset:2304 nt
    ds_read_b128 v[16:19], v8 offset:1280
    s_waitcnt lgkmcnt(1)
    v_lshlrev_b32 v28, 16, v24
    v_lshlrev_b32 v29, 16, v25
    v_lshlrev_b32 v30, 16, v26
    v_lshlrev_b32 v31, 16, v27
    s_add_u32 s61, s60, 360448
    s_waitcnt vmcnt(11)
    v_dot2c_f32_bf16 v32, v80, v24
    v_dot2c_f32_bf16 v33, v80, v28
    v_dot2c_f32_bf16 v34, v81, v24
    v_dot2c_f32_bf16 v35, v81, v28
    v_dot2c_f32_bf16 v36, v82, v24
    v_dot2c_f32_bf16 v37, v82, v28
    v_dot2c_f32_bf16 v38, v83, v24
    v_dot2c_f32_bf16 v39, v83, v28
    buffer_load_dwordx4 v[80:83], v2, s[12:15], s61 offen offset:0 nt
    s_waitcnt vmcnt(11)
    v_dot2c_f32_bf16 v32, v84, v25
    v_dot2c_f32_bf16 v33, v84, v29
    v_dot2c_f32_bf16 v34, v85, v25
    v_dot2c_f32_bf16 v35, v85, v29
    v_dot2c_f32_bf16 v36, v86, v25
    v_dot2c_f32_bf16 v37, v86, v29
    v_dot2c_f32_bf16 v38, v87, v25
    v_dot2c_f32_bf16 v39, v87, v29
    buffer_load_dwordx4 v[84:87], v2, s[12:15], s61 offen offset:256 nt
    s_waitcnt vmcnt(11)
    v_dot2c_f32_bf16 v32, v88, v26
    v_dot2c_f32_bf16 v33, v88, v30
    v_dot2c_f32_bf16 v34, v89, v26
    v_dot2c_f32_bf16 v35, v89, v30
    v_dot2c_f32_bf16 v36, v90, v26
    v_dot2c_f32_bf16 v37, v90, v30
    v_dot2c_f32_bf16 v38, v91, v26
    v_dot2c_f32_bf16 v39, v91, v30
    buffer_load_dwordx4 v[88:91], v2, s[12:15], s61 offen offset:2048 nt
    s_waitcnt vmcnt(11)
    v_dot2c_f32_bf16 v32, v92, v27
    v_dot2c_f32_bf16 v33, v92, v31
    v_dot2c_f32_bf16 v34, v93, v27
    v_dot2c_f32_bf16 v35, v93, v31
    v_dot2c_f32_bf16 v36, v94, v27
    v_dot2c_f32_bf16 v37, v94, v31
    v_dot2c_f32_bf16 v38, v95, v27
    v_dot2c_f32_bf16 v39, v95, v31
    buffer_load_dwordx4 v[92:95], v2, s[12:15], s61 offen offset:2304 nt
    ds_read_b128 v[24:27], v8 offset:1344
    s_waitcnt lgkmcnt(1)
    v_lshlrev_b32 v20, 16, v16
    v_lshlrev_b32 v21, 16, v17
    v_lshlrev_b32 v22, 16, v18
    v_lshlrev_b32 v23, 16, v19
    s_add_u32 s61, s60, 376832
    s_waitcnt vmcnt(11)
    v_dot2c_f32_bf16 v32, v96, v16
    v_dot2c_f32_bf16 v33, v96, v20
    v_dot2c_f32_bf16 v34, v97, v16
    v_dot2c_f32_bf16 v35, v97, v20
    v_dot2c_f32_bf16 v36, v98, v16
    v_dot2c_f32_bf16 v37, v98, v20
    v_dot2c_f32_bf16 v38, v99, v16
    v_dot2c_f32_bf16 v39, v99, v20
    buffer_load_dwordx4 v[96:99], v2, s[12:15], s61 offen offset:0 nt
    s_waitcnt vmcnt(11)
    v_dot2c_f32_bf16 v32, v100, v17
    v_dot2c_f32_bf16 v33, v100, v21
    v_dot2c_f32_bf16 v34, v101, v17
    v_dot2c_f32_bf16 v35, v101, v21
    v_dot2c_f32_bf16 v36, v102, v17
    v_dot2c_f32_bf16 v37, v102, v21
    v_dot2c_f32_bf16 v38, v103, v17
    v_dot2c_f32_bf16 v39, v103, v21
    buffer_load_dwordx4 v[100:103], v2, s[12:15], s61 offen offset:256 nt
    s_waitcnt vmcnt(11)
    v_dot2c_f32_bf16 v32, v104, v18
    v_dot2c_f32_bf16 v33, v104, v22
    v_dot2c_f32_bf16 v34, v105, v18
    v_dot2c_f32_bf16 v35, v105, v22
    v_dot2c_f32_bf16 v36, v106, v18
    v_dot2c_f32_bf16 v37, v106, v22
    v_dot2c_f32_bf16 v38, v107, v18
    v_dot2c_f32_bf16 v39, v107, v22
    buffer_load_dwordx4 v[104:107], v2, s[12:15], s61 offen offset:2048 nt
    s_waitcnt vmcnt(11)
    v_dot2c_f32_bf16 v32, v108, v19
    v_dot2c_f32_bf16 v33, v108, v23
    v_dot2c_f32_bf16 v34, v109, v19
    v_dot2c_f32_bf16 v35, v109, v23
    v_dot2c_f32_bf16 v36, v110, v19
    v_dot2c_f32_bf16 v37, v110, v23
    v_dot2c_f32_bf16 v38, v111, v19
    v_dot2c_f32_bf16 v39, v111, v23
    buffer_load_dwordx4 v[108:111], v2, s[12:15], s61 offen offset:2304 nt
    ds_read_b128 v[16:19], v8 offset:1408
    s_waitcnt lgkmcnt(1)
    v_lshlrev_b32 v28, 16, v24
    v_lshlrev_b32 v29, 16, v25
    v_lshlrev_b32 v30, 16, v26
    v_lshlrev_b32 v31, 16, v27
    s_add_u32 s61, s60, 393216
    s_waitcnt vmcnt(11)
    v_dot2c_f32_bf16 v32, v64, v24
    v_dot2c_f32_bf16 v33, v64, v28
    v_dot2c_f32_bf16 v34, v65, v24
    v_dot2c_f32_bf16 v35, v65, v28
    v_dot2c_f32_bf16 v36, v66, v24
    v_dot2c_f32_bf16 v37, v66, v28
    v_dot2c_f32_bf16 v38, v67, v24
    v_dot2c_f32_bf16 v39, v67, v28
    buffer_load_dwordx4 v[64:67], v2, s[12:15], s61 offen offset:0 nt
    s_waitcnt vmcnt(11)
    v_dot2c_f32_bf16 v32, v68, v25
    v_dot2c_f32_bf16 v33, v68, v29
    v_dot2c_f32_bf16 v34, v69, v25
    v_dot2c_f32_bf16 v35, v69, v29
    v_dot2c_f32_bf16 v36, v70, v25
    v_dot2c_f32_bf16 v37, v70, v29
    v_dot2c_f32_bf16 v38, v71, v25
    v_dot2c_f32_bf16 v39, v71, v29
    buffer_load_dwordx4 v[68:71], v2, s[12:15], s61 offen offset:256 nt
    s_waitcnt vmcnt(11)
    v_dot2c_f32_bf16 v32, v72, v26
    v_dot2c_f32_bf16 v33, v72, v30
    v_dot2c_f32_bf16 v34, v73, v26
    v_dot2c_f32_bf16 v35, v73, v30
    v_dot2c_f32_bf16 v36, v74, v26
    v_dot2c_f32_bf16 v37, v74, v30
    v_dot2c_f32_bf16 v38, v75, v26
    v_dot2c_f32_bf16 v39, v75, v30
    buffer_load_dwordx4 v[72:75], v2, s[12:15], s61 offen offset:2048 nt
    s_waitcnt vmcnt(11)
    v_dot2c_f32_bf16 v32, v76, v27
    v_dot2c_f32_bf16 v33, v76, v31
    v_dot2c_f32_bf16 v34, v77, v27
    v_dot2c_f32_bf16 v35, v77, v31
    v_dot2c_f32_bf16 v36, v78, v27
    v_dot2c_f32_bf16 v37, v78, v31
    v_dot2c_f32_bf16 v38, v79, v27
    v_dot2c_f32_bf16 v39, v79, v31
    buffer_load_dwordx4 v[76:79], v2, s[12:15], s61 offen offset:2304 nt
    ds_read_b128 v[24:27], v8 offset:1472
    s_waitcnt lgkmcnt(1)
    v_lshlrev_b32 v20, 16, v16
    v_lshlrev_b32 v21, 16, v17
    v_lshlrev_b32 v22, 16, v18
    v_lshlrev_b32 v23, 16, v19
    s_waitcnt vmcnt(11)
    v_readfirstlane_b32 s68, v60
    s_add_u32 s68, s68, 1
    s_and_b32 s69, s68, 0xfff
    s_lshl_b32 s69, s69, 12
    s_add_u32 s69, s69, s99
    s_sub_u32 s68, s68, s101
    s_cmp_ge_u32 s68, s64
    s_cselect_b32 s96, s69, 0x10000000
    v_dot2c_f32_bf16 v32, v80, v16
    v_dot2c_f32_bf16 v33, v80, v20
    v_dot2c_f32_bf16 v34, v81, v16
    v_dot2c_f32_bf16 v35, v81, v20
    v_dot2c_f32_bf16 v36, v82, v16
    v_dot2c_f32_bf16 v37, v82, v20
    v_dot2c_f32_bf16 v38, v83, v16
    v_dot2c_f32_bf16 v39, v83, v20
    buffer_load_dwordx4 v[80:83], v9, s[8:11], s96 offen offset:0 nt
    s_waitcnt vmcnt(11)
    v_dot2c_f32_bf16 v32, v84, v17
    v_dot2c_f32_bf16 v33, v84, v21
    v_dot2c_f32_bf16 v34, v85, v17
    v_dot2c_f32_bf16 v35, v85, v21
    v_dot2c_f32_bf16 v36, v86, v17
    v_dot2c_f32_bf16 v37, v86, v21
    v_dot2c_f32_bf16 v38, v87, v17
    v_dot2c_f32_bf16 v39, v87, v21
    buffer_load_dwordx4 v[84:87], v9, s[8:11], s96 offen offset:128 nt
    s_waitcnt vmcnt(11)
    v_dot2c_f32_bf16 v32, v88, v18
    v_dot2c_f32_bf16 v33, v88, v22
    v_dot2c_f32_bf16 v34, v89, v18
    v_dot2c_f32_bf16 v35, v89, v22
    v_dot2c_f32_bf16 v36, v90, v18
    v_dot2c_f32_bf16 v37, v90, v22
    v_dot2c_f32_bf16 v38, v91, v18
    v_dot2c_f32_bf16 v39, v91, v22
    buffer_load_dwordx4 v[88:91], v9, s[8:11], s96 offen offset:2048 nt
    s_waitcnt vmcnt(11)
    v_dot2c_f32_bf16 v32, v92, v19
    v_dot2c_f32_bf16 v33, v92, v23
    v_dot2c_f32_bf16 v34, v93, v19
    v_dot2c_f32_bf16 v35, v93, v23
    v_dot2c_f32_bf16 v36, v94, v19
    v_dot2c_f32_bf16 v37, v94, v23
    v_dot2c_f32_bf16 v38, v95, v19
    v_dot2c_f32_bf16 v39, v95, v23
    buffer_load_dwordx4 v[92:95], v9, s[8:11], s96 offen offset:2176 nt
    ds_read_b128 v[16:19], v8 offset:1536
    s_waitcnt lgkmcnt(1)
    v_lshlrev_b32 v28, 16, v24
    v_lshlrev_b32 v29, 16, v25
    v_lshlrev_b32 v30, 16, v26
    v_lshlrev_b32 v31, 16, v27
    s_cmp_eq_u32 s62, 0
    s_cbranch_scc1 L_13
    s_lshl_b32 s68, s5, 2
    s_add_u32 s68, s68, s3
    s_mul_i32 s68, s68, 3
    s_add_u32 s68, s68, 4225
    v_mov_b32 v62, s68
    s_branch L_14
L_13:
    v_mov_b32 v62, 1
    s_mov_b64 exec, 1
    buffer_atomic_add v62, off, s[16:19], s100 offset:3840 sc0 sc1
    s_mov_b64 exec, -1
L_14:
    s_waitcnt vmcnt(11)
    v_dot2c_f32_bf16 v32, v96, v24
    v_dot2c_f32_bf16 v33, v96, v28
    v_dot2c_f32_bf16 v34, v97, v24
    v_dot2c_f32_bf16 v35, v97, v28
    v_dot2c_f32_bf16 v36, v98, v24
    v_dot2c_f32_bf16 v37, v98, v28
    v_dot2c_f32_bf16 v38, v99, v24
    v_dot2c_f32_bf16 v39, v99, v28
    buffer_load_dwordx4 v[96:99], v2, s[12:15], s96 offen offset:0 nt
    s_waitcnt vmcnt(11)
    v_dot2c_f32_bf16 v32, v100, v25
    v_dot2c_f32_bf16 v33, v100, v29
    v_dot2c_f32_bf16 v34, v101, v25
    v_dot2c_f32_bf16 v35, v101, v29
    v_dot2c_f32_bf16 v36, v102, v25
    v_dot2c_f32_bf16 v37, v102, v29
    v_dot2c_f32_bf16 v38, v103, v25
    v_dot2c_f32_bf16 v39, v103, v29
    buffer_load_dwordx4 v[100:103], v2, s[12:15], s96 offen offset:256 nt
    s_waitcnt vmcnt(11)
    v_dot2c_f32_bf16 v32, v104, v26
    v_dot2c_f32_bf16 v33, v104, v30
    v_dot2c_f32_bf16 v34, v105, v26
    v_dot2c_f32_bf16 v35, v105, v30
    v_dot2c_f32_bf16 v36, v106, v26
    v_dot2c_f32_bf16 v37, v106, v30
    v_dot2c_f32_bf16 v38, v107, v26
    v_dot2c_f32_bf16 v39, v107, v30
    buffer_load_dwordx4 v[104:107], v2, s[12:15], s96 offen offset:2048 nt
    s_waitcnt vmcnt(11)
    v_dot2c_f32_bf16 v32, v108, v27
    v_dot2c_f32_bf16 v33, v108, v31
    v_dot2c_f32_bf16 v34, v109, v27
    v_dot2c_f32_bf16 v35, v109, v31
    v_dot2c_f32_bf16 v36, v110, v27
    v_dot2c_f32_bf16 v37, v110, v31
    v_dot2c_f32_bf16 v38, v111, v27
    v_dot2c_f32_bf16 v39, v111, v31
    buffer_load_dwordx4 v[108:111], v2, s[12:15], s96 offen offset:2304 nt
    s_waitcnt lgkmcnt(0)
    v_lshlrev_b32 v20, 16, v16
    v_lshlrev_b32 v21, 16, v17
    v_lshlrev_b32 v22, 16, v18
    v_lshlrev_b32 v23, 16, v19
    s_waitcnt vmcnt(11)
    v_readfirstlane_b32 s68, v61
    s_add_u32 s68, s68, 1
    s_and_b32 s69, s68, 0xfff
    s_lshl_b32 s69, s69, 12
    s_add_u32 s69, s69, s99
    s_sub_u32 s68, s68, s101
    s_cmp_ge_u32 s68, s64
    s_cselect_b32 s97, s69, 0x10000000
    v_dot2c_f32_bf16 v32, v64, v16
    v_dot2c_f32_bf16 v33, v64, v20
    v_dot2c_f32_bf16 v34, v65, v16
    v_dot2c_f32_bf16 v35, v65, v20
    v_dot2c_f32_bf16 v36, v66, v16
    v_dot2c_f32_bf16 v37, v66, v20
    v_dot2c_f32_bf16 v38, v67, v16
    v_dot2c_f32_bf16 v39, v67, v20
    buffer_load_dwordx4 v[64:67], v9, s[8:11], s97 offen offset:0 nt
    s_waitcnt vmcnt(11)
    v_dot2c_f32_bf16 v32, v68, v17
    v_dot2c_f32_bf16 v33, v68, v21
    v_dot2c_f32_bf16 v34, v69, v17
    v_dot2c_f32_bf16 v35, v69, v21
    v_dot2c_f32_bf16 v36, v70, v17
    v_dot2c_f32_bf16 v37, v70, v21
    v_dot2c_f32_bf16 v38, v71, v17
    v_dot2c_f32_bf16 v39, v71, v21
    buffer_load_dwordx4 v[68:71], v9, s[8:11], s97 offen offset:128 nt
    s_waitcnt vmcnt(11)
    v_dot2c_f32_bf16 v32, v72, v18
    v_dot2c_f32_bf16 v33, v72, v22
    v_dot2c_f32_bf16 v34, v73, v18
    v_dot2c_f32_bf16 v35, v73, v22
    v_dot2c_f32_bf16 v36, v74, v18
    v_dot2c_f32_bf16 v37, v74, v22
    v_dot2c_f32_bf16 v38, v75, v18
    v_dot2c_f32_bf16 v39, v75, v22
    buffer_load_dwordx4 v[72:75], v9, s[8:11], s97 offen offset:2048 nt
    s_waitcnt vmcnt(11)
    v_dot2c_f32_bf16 v32, v76, v19
    v_dot2c_f32_bf16 v33, v76, v23
    v_dot2c_f32_bf16 v34, v77, v19
    v_dot2c_f32_bf16 v35, v77, v23
    v_dot2c_f32_bf16 v36, v78, v19
    v_dot2c_f32_bf16 v37, v78, v23
    v_dot2c_f32_bf16 v38, v79, v19
    v_dot2c_f32_bf16 v39, v79, v23
    buffer_load_dwordx4 v[76:79], v9, s[8:11], s97 offen offset:2176 nt
    v_mov_b32 v63, 0
L_DYN:
    s_cmp_eq_u32 s96, 0x10000000
    s_cbranch_scc1 L_DYN_END
    s_waitcnt vmcnt(8)
    v_mfma_f32_16x16x32_bf16 v[48:51], v[80:83], v[40:43], 0
    v_mfma_f32_16x16x32_bf16 v[48:51], v[84:87], v[44:47], v[48:51]
    v_mfma_f32_16x16x32_bf16 v[52:55], v[88:91], v[40:43], 0
    v_mfma_f32_16x16x32_bf16 v[52:55], v[92:95], v[44:47], v[52:55]
    v_mov_b32 v60, 1
    s_mov_b64 exec, 1
    buffer_atomic_add v60, off, s[16:19], s100 offset:3840 sc0 sc1
    s_mov_b64 exec, -1
    buffer_load_dwordx4 v[80:83], v2, s[12:15], s97 offen offset:0 nt
    buffer_load_dwordx4 v[84:87], v2, s[12:15], s97 offen offset:256 nt
    buffer_load_dwordx4 v[88:91], v2, s[12:15], s97 offen offset:2048 nt
    buffer_load_dwordx4 v[92:95], v2, s[12:15], s97 offen offset:2304 nt
    s_nop 3
    v_cndmask_b32_e64 v24, v49, v48, s[52:53]
    v_cndmask_b32_e64 v25, v51, v50, s[52:53]
    v_cndmask_b32_e64 v26, v53, v52, s[52:53]
    v_cndmask_b32_e64 v27, v55, v54, s[52:53]
    v_add_f32_dpp v56, v24, v24 quad_perm:[1,0,3,2] row_mask:0xf bank_mask:0xf
    v_add_f32_dpp v57, v25, v25 quad_perm:[1,0,3,2] row_mask:0xf bank_mask:0xf
    v_add_f32_dpp v58, v26, v26 quad_perm:[1,0,3,2] row_mask:0xf bank_mask:0xf
    v_add_f32_dpp v59, v27, v27 quad_perm:[1,0,3,2] row_mask:0xf bank_mask:0xf
    v_max3_f32 v13, v56, v57, v58
    v_max_f32 v13, v13, v59
    v_mul_f32 v13, s66, v13
    v_cmp_gt_f32 vcc, v13, v12
    s_cbranch_vccnz RESC_15
RBACK_16:
    v_fma_f32 v56, v56, s66, -v12
    v_fma_f32 v57, v57, s66, -v12
    v_fma_f32 v58, v58, s66, -v12
    v_fma_f32 v59, v59, s66, -v12
    v_exp_f32 v56, v56
    v_exp_f32 v57, v57
    v_exp_f32 v58, v58
    v_exp_f32 v59, v59
    s_nop 0
    v_add_f32 v63, v63, v56
    v_cvt_pk_bf16_f32 v16, v56, 0
    v_add_f32 v63, v63, v57
    v_cvt_pk_bf16_f32 v17, v57, 0
    v_add_f32 v63, v63, v58
    v_cvt_pk_bf16_f32 v18, v58, 0
    v_add_f32 v63, v63, v59
    v_cvt_pk_bf16_f32 v19, v59, 0
    v_lshlrev_b32 v20, 16, v16
    v_lshlrev_b32 v21, 16, v17
    v_lshlrev_b32 v22, 16, v18
    v_lshlrev_b32 v23, 16, v19
    s_waitcnt vmcnt(11)
    v_readfirstlane_b32 s68, v62
    s_add_u32 s68, s68, 1
    s_and_b32 s69, s68, 0xfff
    s_lshl_b32 s69, s69, 12
    s_add_u32 s69, s69, s99
    s_sub_u32 s68, s68, s101
    s_cmp_ge_u32 s68, s64
    s_cselect_b32 s98, s69, 0x10000000
    v_dot2c_f32_bf16 v32, v96, v16
    v_dot2c_f32_bf16 v33, v96, v20
    v_dot2c_f32_bf16 v34, v97, v16
    v_dot2c_f32_bf16 v35, v97, v20
    v_dot2c_f32_bf16 v36, v98, v16
    v_dot2c_f32_bf16 v37, v98, v20
    v_dot2c_f32_bf16 v38, v99, v16
    v_dot2c_f32_bf16 v39, v99, v20
    buffer_load_dwordx4 v[96:99], v9, s[8:11], s98 offen offset:0 nt
    s_waitcnt vmcnt(11)
    v_dot2c_f32_bf16 v32, v100, v17
    v_dot2c_f32_bf16 v33, v100, v21
    v_dot2c_f32_bf16 v34, v101, v17
    v_dot2c_f32_bf16 v35, v101, v21
    v_dot2c_f32_bf16 v36, v102, v17
    v_dot2c_f32_bf16 v37, v102, v21
    v_dot2c_f32_bf16 v38, v103, v17
    v_dot2c_f32_bf16 v39, v103, v21
    buffer_load_dwordx4 v[100:103], v9, s[8:11], s98 offen offset:128 nt
    s_waitcnt vmcnt(11)
    v_dot2c_f32_bf16 v32, v104, v18
    v_dot2c_f32_bf16 v33, v104, v22
    v_dot2c_f32_bf16 v34, v105, v18
    v_dot2c_f32_bf16 v35, v105, v22
    v_dot2c_f32_bf16 v36, v106, v18
    v_dot2c_f32_bf16 v37, v106, v22
    v_dot2c_f32_bf16 v38, v107, v18
    v_dot2c_f32_bf16 v39, v107, v22
    buffer_load_dwordx4 v[104:107], v9, s[8:11], s98 offen offset:2048 nt
    s_waitcnt vmcnt(11)
    v_dot2c_f32_bf16 v32, v108, v19
    v_dot2c_f32_bf16 v33, v108, v23
    v_dot2c_f32_bf16 v34, v109, v19
    v_dot2c_f32_bf16 v35, v109, v23
    v_dot2c_f32_bf16 v36, v110, v19
    v_dot2c_f32_bf16 v37, v110, v23
    v_dot2c_f32_bf16 v38, v111, v19
    v_dot2c_f32_bf16 v39, v111, v23
    buffer_load_dwordx4 v[108:111], v9, s[8:11], s98 offen offset:2176 nt
    s_cmp_eq_u32 s97, 0x10000000
    s_cbranch_scc1 L_DYN_END
    s_waitcnt vmcnt(8)
    v_mfma_f32_16x16x32_bf16 v[48:51], v[64:67], v[40:43], 0
    v_mfma_f32_16x16x32_bf16 v[48:51], v[68:71], v[44:47], v[48:51]
    v_mfma_f32_16x16x32_bf16 v[52:55], v[72:75], v[40:43], 0
    v_mfma_f32_16x16x32_bf16 v[52:55], v[76:79], v[44:47], v[52:55]
    v_mov_b32 v61, 1
    s_mov_b64 exec, 1
    buffer_atomic_add v61, off, s[16:19], s100 offset:3840 sc0 sc1
    s_mov_b64 exec, -1
    buffer_load_dwordx4 v[64:67], v2, s[12:15], s98 offen offset:0 nt
    buffer_load_dwordx4 v[68:71], v2, s[12:15], s98 offen offset:256 nt
    buffer_load_dwordx4 v[72:75], v2, s[12:15], s98 offen offset:2048 nt
    buffer_load_dwordx4 v[76:79], v2, s[12:15], s98 offen offset:2304 nt
    s_nop 3
    v_cndmask_b32_e64 v24, v49, v48, s[52:53]
    v_cndmask_b32_e64 v25, v51, v50, s[52:53]
    v_cndmask_b32_e64 v26, v53, v52, s[52:53]
    v_cndmask_b32_e64 v27, v55, v54, s[52:53]
    v_add_f32_dpp v56, v24, v24 quad_perm:[1,0,3,2] row_mask:0xf bank_mask:0xf
    v_add_f32_dpp v57, v25, v25 quad_perm:[1,0,3,2] row_mask:0xf bank_mask:0xf
    v_add_f32_dpp v58, v26, v26 quad_perm:[1,0,3,2] row_mask:0xf bank_mask:0xf
    v_add_f32_dpp v59, v27, v27 quad_perm:[1,0,3,2] row_mask:0xf bank_mask:0xf
    v_max3_f32 v13, v56, v57, v58
    v_max_f32 v13, v13, v59
    v_mul_f32 v13, s66, v13
    v_cmp_gt_f32 vcc, v13, v12
    s_cbranch_vccnz RESC_17
RBACK_18:
    v_fma_f32 v56, v56, s66, -v12
    v_fma_f32 v57, v57, s66, -v12
    v_fma_f32 v58, v58, s66, -v12
    v_fma_f32 v59, v59, s66, -v12
    v_exp_f32 v56, v56
    v_exp_f32 v57, v57
    v_exp_f32 v58, v58
    v_exp_f32 v59, v59
    s_nop 0
    v_add_f32 v63, v63, v56
    v_cvt_pk_bf16_f32 v16, v56, 0
    v_add_f32 v63, v63, v57
    v_cvt_pk_bf16_f32 v17, v57, 0
    v_add_f32 v63, v63, v58
    v_cvt_pk_bf16_f32 v18, v58, 0
    v_add_f32 v63, v63, v59
    v_cvt_pk_bf16_f32 v19, v59, 0
    v_lshlrev_b32 v20, 16, v16
    v_lshlrev_b32 v21, 16, v17
    v_lshlrev_b32 v22, 16, v18
    v_lshlrev_b32 v23, 16, v19
    s_waitcnt vmcnt(11)
    v_readfirstlane_b32 s68, v60
    s_add_u32 s68, s68, 1
    s_and_b32 s69, s68, 0xfff
    s_lshl_b32 s69, s69, 12
    s_add_u32 s69, s69, s99
    s_sub_u32 s68, s68, s101
    s_cmp_ge_u32 s68, s64
    s_cselect_b32 s96, s69, 0x10000000
    v_dot2c_f32_bf16 v32, v80, v16
    v_dot2c_f32_bf16 v33, v80, v20
    v_dot2c_f32_bf16 v34, v81, v16
    v_dot2c_f32_bf16 v35, v81, v20
    v_dot2c_f32_bf16 v36, v82, v16
    v_dot2c_f32_bf16 v37, v82, v20
    v_dot2c_f32_bf16 v38, v83, v16
    v_dot2c_f32_bf16 v39, v83, v20
    buffer_load_dwordx4 v[80:83], v9, s[8:11], s96 offen offset:0 nt
    s_waitcnt vmcnt(11)
    v_dot2c_f32_bf16 v32, v84, v17
    v_dot2c_f32_bf16 v33, v84, v21
    v_dot2c_f32_bf16 v34, v85, v17
    v_dot2c_f32_bf16 v35, v85, v21
    v_dot2c_f32_bf16 v36, v86, v17
    v_dot2c_f32_bf16 v37, v86, v21
    v_dot2c_f32_bf16 v38, v87, v17
    v_dot2c_f32_bf16 v39, v87, v21
    buffer_load_dwordx4 v[84:87], v9, s[8:11], s96 offen offset:128 nt
    s_waitcnt vmcnt(11)
    v_dot2c_f32_bf16 v32, v88, v18
    v_dot2c_f32_bf16 v33, v88, v22
    v_dot2c_f32_bf16 v34, v89, v18
    v_dot2c_f32_bf16 v35, v89, v22
    v_dot2c_f32_bf16 v36, v90, v18
    v_dot2c_f32_bf16 v37, v90, v22
    v_dot2c_f32_bf16 v38, v91, v18
    v_dot2c_f32_bf16 v39, v91, v22
    buffer_load_dwordx4 v[88:91], v9, s[8:11], s96 offen offset:2048 nt
    s_waitcnt vmcnt(11)
    v_dot2c_f32_bf16 v32, v92, v19
    v_dot2c_f32_bf16 v33, v92, v23
    v_dot2c_f32_bf16 v34, v93, v19
    v_dot2c_f32_bf16 v35, v93, v23
    v_dot2c_f32_bf16 v36, v94, v19
    v_dot2c_f32_bf16 v37, v94, v23
    v_dot2c_f32_bf16 v38, v95, v19
    v_dot2c_f32_bf16 v39, v95, v23
    buffer_load_dwordx4 v[92:95], v9, s[8:11], s96 offen offset:2176 nt
    s_cmp_eq_u32 s98, 0x10000000
    s_cbranch_scc1 L_DYN_END
    s_waitcnt vmcnt(8)
    v_mfma_f32_16x16x32_bf16 v[48:51], v[96:99], v[40:43], 0
    v_mfma_f32_16x16x32_bf16 v[48:51], v[100:103], v[44:47], v[48:51]
    v_mfma_f32_16x16x32_bf16 v[52:55], v[104:107], v[40:43], 0
    v_mfma_f32_16x16x32_bf16 v[52:55], v[108:111], v[44:47], v[52:55]
    v_mov_b32 v62, 1
    s_mov_b64 exec, 1
    buffer_atomic_add v62, off, s[16:19], s100 offset:3840 sc0 sc1
    s_mov_b64 exec, -1
    buffer_load_dwordx4 v[96:99], v2, s[12:15], s96 offen offset:0 nt
    buffer_load_dwordx4 v[100:103], v2, s[12:15], s96 offen offset:256 nt
    buffer_load_dwordx4 v[104:107], v2, s[12:15], s96 offen offset:2048 nt
    buffer_load_dwordx4 v[108:111], v2, s[12:15], s96 offen offset:2304 nt
    s_nop 3
    v_cndmask_b32_e64 v24, v49, v48, s[52:53]
    v_cndmask_b32_e64 v25, v51, v50, s[52:53]
    v_cndmask_b32_e64 v26, v53, v52, s[52:53]
    v_cndmask_b32_e64 v27, v55, v54, s[52:53]
    v_add_f32_dpp v56, v24, v24 quad_perm:[1,0,3,2] row_mask:0xf bank_mask:0xf
    v_add_f32_dpp v57, v25, v25 quad_perm:[1,0,3,2] row_mask:0xf bank_mask:0xf
    v_add_f32_dpp v58, v26, v26 quad_perm:[1,0,3,2] row_mask:0xf bank_mask:0xf
    v_add_f32_dpp v59, v27, v27 quad_perm:[1,0,3,2] row_mask:0xf bank_mask:0xf
    v_max3_f32 v13, v56, v57, v58
    v_max_f32 v13, v13, v59
    v_mul_f32 v13, s66, v13
    v_cmp_gt_f32 vcc, v13, v12
    s_cbranch_vccnz RESC_19
RBACK_20:
    v_fma_f32 v56, v56, s66, -v12
    v_fma_f32 v57, v57, s66, -v12
    v_fma_f32 v58, v58, s66, -v12
    v_fma_f32 v59, v59, s66, -v12
    v_exp_f32 v56, v56
    v_exp_f32 v57, v57
    v_exp_f32 v58, v58
    v_exp_f32 v59, v59
    s_nop 0
    v_add_f32 v63, v63, v56
    v_cvt_pk_bf16_f32 v16, v56, 0
    v_add_f32 v63, v63, v57
    v_cvt_pk_bf16_f32 v17, v57, 0
    v_add_f32 v63, v63, v58
    v_cvt_pk_bf16_f32 v18, v58, 0
    v_add_f32 v63, v63, v59
    v_cvt_pk_bf16_f32 v19, v59, 0
    v_lshlrev_b32 v20, 16, v16
    v_lshlrev_b32 v21, 16, v17
    v_lshlrev_b32 v22, 16, v18
    v_lshlrev_b32 v23, 16, v19
    s_waitcnt vmcnt(11)
    v_readfirstlane_b32 s68, v61
    s_add_u32 s68, s68, 1
    s_and_b32 s69, s68, 0xfff
    s_lshl_b32 s69, s69, 12
    s_add_u32 s69, s69, s99
    s_sub_u32 s68, s68, s101
    s_cmp_ge_u32 s68, s64
    s_cselect_b32 s97, s69, 0x10000000
    v_dot2c_f32_bf16 v32, v64, v16
    v_dot2c_f32_bf16 v33, v64, v20
    v_dot2c_f32_bf16 v34, v65, v16
    v_dot2c_f32_bf16 v35, v65, v20
    v_dot2c_f32_bf16 v36, v66, v16
    v_dot2c_f32_bf16 v37, v66, v20
    v_dot2c_f32_bf16 v38, v67, v16
    v_dot2c_f32_bf16 v39, v67, v20
    buffer_load_dwordx4 v[64:67], v9, s[8:11], s97 offen offset:0 nt
    s_waitcnt vmcnt(11)
    v_dot2c_f32_bf16 v32, v68, v17
    v_dot2c_f32_bf16 v33, v68, v21
    v_dot2c_f32_bf16 v34, v69, v17
    v_dot2c_f32_bf16 v35, v69, v21
    v_dot2c_f32_bf16 v36, v70, v17
    v_dot2c_f32_bf16 v37, v70, v21
    v_dot2c_f32_bf16 v38, v71, v17
    v_dot2c_f32_bf16 v39, v71, v21
    buffer_load_dwordx4 v[68:71], v9, s[8:11], s97 offen offset:128 nt
    s_waitcnt vmcnt(11)
    v_dot2c_f32_bf16 v32, v72, v18
    v_dot2c_f32_bf16 v33, v72, v22
    v_dot2c_f32_bf16 v34, v73, v18
    v_dot2c_f32_bf16 v35, v73, v22
    v_dot2c_f32_bf16 v36, v74, v18
    v_dot2c_f32_bf16 v37, v74, v22
    v_dot2c_f32_bf16 v38, v75, v18
    v_dot2c_f32_bf16 v39, v75, v22
    buffer_load_dwordx4 v[72:75], v9, s[8:11], s97 offen offset:2048 nt
    s_waitcnt vmcnt(11)
    v_dot2c_f32_bf16 v32, v76, v19
    v_dot2c_f32_bf16 v33, v76, v23
    v_dot2c_f32_bf16 v34, v77, v19
    v_dot2c_f32_bf16 v35, v77, v23
    v_dot2c_f32_bf16 v36, v78, v19
    v_dot2c_f32_bf16 v37, v78, v23
    v_dot2c_f32_bf16 v38, v79, v19
    v_dot2c_f32_bf16 v39, v79, v23
    buffer_load_dwordx4 v[76:79], v9, s[8:11], s97 offen offset:2176 nt
    s_branch L_DYN
RESC_15:
    v_mov_b32 v14, v13
    s_nop 1
    v_permlane16_swap_b32 v14, v13
    v_max_f32 v13, v14, v13
    v_mov_b32 v14, v13
    s_nop 1
    v_permlane32_swap_b32 v14, v13
    v_max_f32 v13, v14, v13
    v_max_f32 v13, v13, v12
    v_sub_f32 v14, v12, v13
    v_exp_f32 v14, v14
    v_mov_b32 v12, v13
    s_nop 2
    v_mul_f32 v32, v32, v14
    v_mul_f32 v33, v33, v14
    v_mul_f32 v34, v34, v14
    v_mul_f32 v35, v35, v14
    v_mul_f32 v36, v36, v14
    v_mul_f32 v37, v37, v14
    v_mul_f32 v38, v38, v14
    v_mul_f32 v39, v39, v14
    v_mul_f32 v11, v11, v14
    v_mul_f32 v63, v63, v14
    s_branch RBACK_16
RESC_17:
    v_mov_b32 v14, v13
    s_nop 1
    v_permlane16_swap_b32 v14, v13
    v_max_f32 v13, v14, v13
    v_mov_b32 v14, v13
    s_nop 1
    v_permlane32_swap_b32 v14, v13
    v_max_f32 v13, v14, v13
    v_max_f32 v13, v13, v12
    v_sub_f32 v14, v12, v13
    v_exp_f32 v14, v14
    v_mov_b32 v12, v13
    s_nop 2
    v_mul_f32 v32, v32, v14
    v_mul_f32 v33, v33, v14
    v_mul_f32 v34, v34, v14
    v_mul_f32 v35, v35, v14
    v_mul_f32 v36, v36, v14
    v_mul_f32 v37, v37, v14
    v_mul_f32 v38, v38, v14
    v_mul_f32 v39, v39, v14
    v_mul_f32 v11, v11, v14
    v_mul_f32 v63, v63, v14
    s_branch RBACK_18
RESC_19:
    v_mov_b32 v14, v13
    s_nop 1
    v_permlane16_swap_b32 v14, v13
    v_max_f32 v13, v14, v13
    v_mov_b32 v14, v13
    s_nop 1
    v_permlane32_swap_b32 v14, v13
    v_max_f32 v13, v14, v13
    v_max_f32 v13, v13, v12
    v_sub_f32 v14, v12, v13
    v_exp_f32 v14, v14
    v_mov_b32 v12, v13
    s_nop 2
    v_mul_f32 v32, v32, v14
    v_mul_f32 v33, v33, v14
    v_mul_f32 v34, v34, v14
    v_mul_f32 v35, v35, v14
    v_mul_f32 v36, v36, v14
    v_mul_f32 v37, v37, v14
    v_mul_f32 v38, v38, v14
    v_mul_f32 v39, v39, v14
    v_mul_f32 v11, v11, v14
    v_mul_f32 v63, v63, v14
    s_branch RBACK_20
L_DYN_END:
    v_mov_b32 v14, v63
    s_nop 1
    v_permlane16_swap_b32 v14, v63
    v_add_f32 v63, v14, v63
    v_mov_b32 v14, v63
    s_nop 1
    v_permlane32_swap_b32 v14, v63
    v_add_f32 v63, v14, v63
    v_add_f32 v11, v11, v63
    v_lshrrev_b32 v13, 4, v1
    v_lshlrev_b32 v13, 10, v13
    v_and_b32 v15, 15, v1
    v_lshl_add_u32 v13, v15, 3, v13
    v_lshrrev_b32 v14, 4, v1
    v_mul_u32_u24 v14, 11008, v14
    v_and_b32 v15, 7, v1
    v_min_u32 v15, 5, v15
    v_lshl_add_u32 v14, v15, 4, v14
    v_lshrrev_b32 v40, 4, v1
    v_lshlrev_b32 v40, 15, v40
    v_and_b32 v15, 15, v1
    v_lshl_add_u32 v40, v15, 4, v40
    s_add_u32 s69, s76, 0
    buffer_load_dwordx2 v[64:65], v13, s[24:27], s69 offen nt
    s_add_u32 s69, s76, 4096
    buffer_load_dwordx2 v[66:67], v13, s[24:27], s69 offen nt
    s_add_u32 s69, s76, 8192
    buffer_load_dwordx2 v[68:69], v13, s[24:27], s69 offen nt
    s_add_u32 s69, s76, 12288
    buffer_load_dwordx2 v[70:71], v13, s[24:27], s69 offen nt
    s_add_u32 s69, s76, 16384
    buffer_load_dwordx2 v[72:73], v13, s[24:27], s69 offen nt
    s_add_u32 s69, s76, 20480
    buffer_load_dwordx2 v[74:75], v13, s[24:27], s69 offen nt
    s_add_u32 s69, s76, 24576
    buffer_load_dwordx2 v[76:77], v13, s[24:27], s69 offen nt
    s_add_u32 s69, s76, 28672
    buffer_load_dwordx2 v[78:79], v13, s[24:27], s69 offen nt
    s_add_u32 s69, s77, 0
    s_mov_b64 exec, s[56:57]
    buffer_load_dwordx4 v[80:83], v14, s[28:31], s69 offen nt
    s_mov_b64 exec, s[58:59]
    buffer_load_dwordx4 v[80:83], v14, s[32:35], s69 offen nt
    s_mov_b64 exec, -1
    s_add_u32 s69, s77, 2752
    s_mov_b64 exec, s[56:57]
    buffer_load_dwordx4 v[84:87], v14, s[28:31], s69 offen nt
    s_mov_b64 exec, s[58:59]
    buffer_load_dwordx4 v[84:87], v14, s[32:35], s69 offen nt
    s_mov_b64 exec, -1
    s_add_u32 s69, s77, 5504
    s_mov_b64 exec, s[56:57]
    buffer_load_dwordx4 v[88:91], v14, s[28:31], s69 offen nt
    s_mov_b64 exec, s[58:59]
    buffer_load_dwordx4 v[88:91], v14, s[32:35], s69 offen nt
    s_mov_b64 exec, -1
    s_add_u32 s69, s77, 8256
    s_mov_b64 exec, s[56:57]
    buffer_load_dwordx4 v[92:95], v14, s[28:31], s69 offen nt
    s_mov_b64 exec, s[58:59]
    buffer_load_dwordx4 v[92:95], v14, s[32:35], s69 offen nt
    s_mov_b64 exec, -1
    s_add_u32 s69, s78, 0
    buffer_load_dwordx2 v[48:49], v13, s[36:39], s69 offen nt
    s_add_u32 s69, s78, 16384
    buffer_load_dwordx2 v[50:51], v13, s[36:39], s69 offen nt
    s_add_u32 s69, s78, 32768
    buffer_load_dwordx2 v[52:53], v13, s[36:39], s69 offen nt
    s_nop 2
    v_permlane16_swap_b32 v32, v33
    v_permlane16_swap_b32 v34, v35
    v_add_f32 v32, v32, v33
    v_add_f32 v34, v34, v35
    s_nop 1
    v_permlane32_swap_b32 v32, v34
    v_add_f32 v32, v32, v34
    s_nop 2
    v_permlane16_swap_b32 v36, v37
    v_permlane16_swap_b32 v38, v39
    v_add_f32 v36, v36, v37
    v_add_f32 v38, v38, v39
    s_nop 1
    v_permlane32_swap_b32 v36, v38
    v_add_f32 v36, v36, v38
    v_and_b32 v13, 15, v1
    v_lshlrev_b32 v13, 5, v13
    v_lshrrev_b32 v15, 4, v1
    v_lshl_add_u32 v13, v15, 2, v13
    s_lshl_b32 s69, s3, 11
    v_add_u32 v13, s69, v13
    ds_write_b32 v13, v32
    ds_write_b32 v13, v36 offset:16
    v_mov_b32 v16, v12
    v_mov_b32 v17, v11
    s_lshl_b32 s69, s3, 11
    v_mov_b32 v13, s69
    s_mov_b64 exec, 1
    ds_write_b64 v13, v[16:17] offset:1536
    s_mov_b64 exec, -1
    s_waitcnt lgkmcnt(0)
    s_barrier
    s_cmp_ge_u32 s3, 2
    s_cbranch_scc1 L_21
    v_lshlrev_b32 v13, 2, v0
    v_mov_b32 v14, 0
    ds_read_b32 v16, v13 offset:0
    ds_read_b64 v[20:21], v14 offset:1536
    ds_read_b32 v17, v13 offset:2048
    ds_read_b64 v[22:23], v14 offset:3584
    ds_read_b32 v18, v13 offset:4096
    ds_read_b64 v[24:25], v14 offset:5632
    ds_read_b32 v19, v13 offset:6144
    ds_read_b64 v[26:27], v14 offset:7680
    s_waitcnt lgkmcnt(0)
    v_max3_f32 v28, v20, v22, v24
    v_max_f32 v28, v28, v26
    v_sub_f32 v20, v20, v28
    v_sub_f32 v22, v22, v28
    v_sub_f32 v24, v24, v28
    v_sub_f32 v26, v26, v28
    v_exp_f32 v20, v20
    v_exp_f32 v22, v22
    v_exp_f32 v24, v24
    v_exp_f32 v26, v26
    s_nop 0
    v_mul_f32 v30, v16, v20
    v_mul_f32 v29, v21, v20
    v_fmac_f32 v30, v17, v22
    v_fmac_f32 v29, v23, v22
    v_fmac_f32 v30, v18, v24
    v_fmac_f32 v29, v25, v24
    v_fmac_f32 v30, v19, v26
    v_fmac_f32 v29, v27, v26
    s_add_u32 s69, s63, s62
    buffer_store_dword v30, v13, s[16:19], s69 offen offset:1280 sc1
    s_cmp_lg_u32 s3, 0
    s_cbranch_scc1 L_22
    s_mov_b64 exec, 1
    buffer_store_dwordx2 v[28:29], off, s[16:19], s69 offset:1792 sc1
    s_mov_b64 exec, -1
L_22:
    s_sleep 8
POLL_23:
    v_lshlrev_b32 v13, 2, v0
    s_add_u32 s68, s70, s62
    s_add_u32 s69, s68, 0
    buffer_load_dword v16, v13, s[16:19], s69 offen offset:1280 sc1
    buffer_load_dwordx2 v[24:25], off, s[16:19], s69 offset:1792 sc1
    s_add_u32 s69, s68, 262144
    buffer_load_dword v17, v13, s[16:19], s69 offen offset:1280 sc1
    buffer_load_dwordx2 v[26:27], off, s[16:19], s69 offset:1792 sc1
    s_add_u32 s69, s68, 524288
    buffer_load_dword v18, v13, s[16:19], s69 offen offset:1280 sc1
    buffer_load_dwordx2 v[28:29], off, s[16:19], s69 offset:1792 sc1
    s_add_u32 s69, s68, 786432
    buffer_load_dword v19, v13, s[16:19], s69 offen offset:1280 sc1
    buffer_load_dwordx2 v[30:31], off, s[16:19], s69 offset:1792 sc1
    s_add_u32 s69, s68, 1048576
    buffer_load_dword v20, v13, s[16:19], s69 offen offset:1280 sc1
    buffer_load_dwordx2 v[32:33], off, s[16:19], s69 offset:1792 sc1
    s_add_u32 s69, s68, 1310720
    buffer_load_dword v21, v13, s[16:19], s69 offen offset:1280 sc1
    buffer_load_dwordx2 v[34:35], off, s[16:19], s69 offset:1792 sc1
    s_add_u32 s69, s68, 1572864
    buffer_load_dword v22, v13, s[16:19], s69 offen offset:1280 sc1
    buffer_load_dwordx2 v[36:37], off, s[16:19], s69 offset:1792 sc1
    s_add_u32 s69, s68, 1835008
    buffer_load_dword v23, v13, s[16:19], s69 offen offset:1280 sc1
    buffer_load_dwordx2 v[38:39], off, s[16:19], s69 offset:1792 sc1
    s_waitcnt vmcnt(0)
    v_max_u32 v15, v16, v17
    v_max3_u32 v15, v15, v18, v19
    v_max3_u32 v15, v15, v20, v21
    v_max3_u32 v15, v15, v22, v23
    v_max3_u32 v15, v15, v24, v25
    v_max3_u32 v15, v15, v26, v27
    v_max3_u32 v15, v15, v28, v29
    v_max3_u32 v15, v15, v30, v31
    v_max3_u32 v15, v15, v32, v33
    v_max3_u32 v15, v15, v34, v35
    v_max3_u32 v15, v15, v36, v37
    v_max3_u32 v15, v15, v38, v39
    v_cmp_eq_u32 vcc, -1, v15
    s_cbranch_vccz PDONE_24
    s_cmp_eq_u32 s65, 0
    s_cbranch_scc1 PDONE_24
    s_sub_u32 s65, s65, 1
    s_branch POLL_23
PDONE_24:
    v_max3_f32 v40, v24, v26, v28
    v_max3_f32 v40, v40, v30, v32
    v_max3_f32 v40, v40, v34, v36
    v_max_f32 v40, v40, v38
    v_sub_f32 v24, v24, v40
    v_sub_f32 v26, v26, v40
    v_sub_f32 v28, v28, v40
    v_sub_f32 v30, v30, v40
    v_sub_f32 v32, v32, v40
    v_sub_f32 v34, v34, v40
    v_sub_f32 v36, v36, v40
    v_sub_f32 v38, v38, v40
    v_exp_f32 v24, v24
    v_exp_f32 v26, v26
    v_exp_f32 v28, v28
    v_exp_f32 v30, v30
    v_exp_f32 v32, v32
    v_exp_f32 v34, v34
    v_exp_f32 v36, v36
    v_exp_f32 v38, v38
    s_nop 0
    v_mul_f32 v41, v16, v24
    v_mul_f32 v42, v25, v24
    v_fmac_f32 v41, v17, v26
    v_fmac_f32 v42, v27, v26
    v_fmac_f32 v41, v18, v28
    v_fmac_f32 v42, v29, v28
    v_fmac_f32 v41, v19, v30
    v_fmac_f32 v42, v31, v30
    v_fmac_f32 v41, v20, v32
    v_fmac_f32 v42, v33, v32
    v_fmac_f32 v41, v21, v34
    v_fmac_f32 v42, v35, v34
    v_fmac_f32 v41, v22, v36
    v_fmac_f32 v42, v37, v36
    v_fmac_f32 v41, v23, v38
    v_fmac_f32 v42, v39, v38
    v_rcp_f32 v42, v42
    s_nop 0
    v_mul_f32 v41, v41, v42
    v_cvt_pk_bf16_f32 v41, v41, 0
    v_and_b32 v13, 0x60, v0
    v_and_b32 v14, 3, v0
    v_lshl_add_u32 v13, v14, 3, v13
    v_bfe_u32 v14, v0, 2, 3
    v_add_lshl_u32 v13, v13, v14, 2
    ds_write_b32 v13, v41 offset:8192
L_21:
    s_waitcnt vmcnt(0) lgkmcnt(0)
    s_barrier
    v_lshrrev_b32 v13, 4, v1
    v_lshlrev_b32 v13, 5, v13
    s_lshl_b32 s69, s3, 7
    v_add_u32 v13, s69, v13
    ds_read_b128 v[16:19], v13 offset:8192
    ds_read_b128 v[20:23], v13 offset:8208
    s_waitcnt lgkmcnt(0)
    v_lshlrev_b32 v24, 16, v16
    v_lshlrev_b32 v25, 16, v17
    v_lshlrev_b32 v26, 16, v18
    v_lshlrev_b32 v27, 16, v19
    v_lshlrev_b32 v28, 16, v20
    v_lshlrev_b32 v29, 16, v21
    v_lshlrev_b32 v30, 16, v22
    v_lshlrev_b32 v31, 16, v23
    v_dot2_f32_bf16 v32, v64, v16, 0
    v_dot2_f32_bf16 v33, v64, v24, 0
    v_dot2_f32_bf16 v34, v65, v16, 0
    v_dot2_f32_bf16 v35, v65, v24, 0
    v_dot2_f32_bf16 v32, v66, v17, v32
    v_dot2_f32_bf16 v33, v66, v25, v33
    v_dot2_f32_bf16 v34, v67, v17, v34
    v_dot2_f32_bf16 v35, v67, v25, v35
    v_dot2_f32_bf16 v32, v68, v18, v32
    v_dot2_f32_bf16 v33, v68, v26, v33
    v_dot2_f32_bf16 v34, v69, v18, v34
    v_dot2_f32_bf16 v35, v69, v26, v35
    v_dot2_f32_bf16 v32, v70, v19, v32
    v_dot2_f32_bf16 v33, v70, v27, v33
    v_dot2_f32_bf16 v34, v71, v19, v34
    v_dot2_f32_bf16 v35, v71, v27, v35
    v_dot2_f32_bf16 v32, v72, v20, v32
    v_dot2_f32_bf16 v33, v72, v28, v33
    v_dot2_f32_bf16 v34, v73, v20, v34
    v_dot2_f32_bf16 v35, v73, v28, v35
    v_dot2_f32_bf16 v32, v74, v21, v32
    v_dot2_f32_bf16 v33, v74, v29, v33
    v_dot2_f32_bf16 v34, v75, v21, v34
    v_dot2_f32_bf16 v35, v75, v29, v35
    v_dot2_f32_bf16 v32, v76, v22, v32
    v_dot2_f32_bf16 v33, v76, v30, v33
    v_dot2_f32_bf16 v34, v77, v22, v34
    v_dot2_f32_bf16 v35, v77, v30, v35
    v_dot2_f32_bf16 v32, v78, v23, v32
    v_dot2_f32_bf16 v33, v78, v31, v33
    v_dot2_f32_bf16 v34, v79, v23, v34
    v_dot2_f32_bf16 v35, v79, v31, v35
    s_nop 2
    v_permlane16_swap_b32 v32, v33
    v_permlane16_swap_b32 v34, v35
    v_add_f32 v32, v32, v33
    v_add_f32 v34, v34, v35
    s_nop 1
    v_permlane32_swap_b32 v32, v34
    v_add_f32 v32, v32, v34
    v_and_b32 v13, 15, v1
    v_lshlrev_b32 v13, 4, v13
    v_lshrrev_b32 v15, 4, v1
    v_lshl_add_u32 v13, v15, 2, v13
    s_lshl_b32 s69, s3, 11
    v_add_u32 v13, s69, v13
    ds_write_b32 v13, v32 offset:1024
    s_waitcnt lgkmcnt(0)
    s_barrier
    s_cmp_ge_u32 s3, 1
    s_cbranch_scc1 L_25
    v_lshlrev_b32 v13, 2, v0
    ds_read_b32 v16, v13 offset:1024
    ds_read_b32 v17, v13 offset:3072
    ds_read_b32 v18, v13 offset:5120
    ds_read_b32 v19, v13 offset:7168
    s_add_u32 s69, s63, s62
    s_waitcnt lgkmcnt(0)
    v_add_f32 v16, v16, v17
    v_add_f32 v18, v18, v19
    v_add_f32 v16, v16, v18
    s_cmp_lg_u32 s7, 0
    s_cbranch_scc1 L_26
    buffer_store_dword v16, v13, s[16:19], s69 offen offset:2048 sc1
    s_branch L_27
L_26:
    buffer_store_dword v16, v13, s[16:19], s69 offen offset:2048
L_27:
L_25:
    v_dot2_f32_bf16 v32, v80, s67, 0
    v_dot2_f32_bf16 v33, v80, s74, 0
    v_dot2_f32_bf16 v34, v81, s67, 0
    v_dot2_f32_bf16 v35, v81, s74, 0
    v_dot2_f32_bf16 v36, v82, s67, 0
    v_dot2_f32_bf16 v37, v82, s74, 0
    v_dot2_f32_bf16 v38, v83, s67, 0
    v_dot2_f32_bf16 v39, v83, s74, 0
    v_dot2_f32_bf16 v32, v84, s67, v32
    v_dot2_f32_bf16 v33, v84, s74, v33
    v_dot2_f32_bf16 v34, v85, s67, v34
    v_dot2_f32_bf16 v35, v85, s74, v35
    v_dot2_f32_bf16 v36, v86, s67, v36
    v_dot2_f32_bf16 v37, v86, s74, v37
    v_dot2_f32_bf16 v38, v87, s67, v38
    v_dot2_f32_bf16 v39, v87, s74, v39
    v_dot2_f32_bf16 v32, v88, s67, v32
    v_dot2_f32_bf16 v33, v88, s74, v33
    v_dot2_f32_bf16 v34, v89, s67, v34
    v_dot2_f32_bf16 v35, v89, s74, v35
    v_dot2_f32_bf16 v36, v90, s67, v36
    v_dot2_f32_bf16 v37, v90, s74, v37
    v_dot2_f32_bf16 v38, v91, s67, v38
    v_dot2_f32_bf16 v39, v91, s74, v39
    v_dot2_f32_bf16 v32, v92, s67, v32
    v_dot2_f32_bf16 v33, v92, s74, v33
    v_dot2_f32_bf16 v34, v93, s67, v34
    v_dot2_f32_bf16 v35, v93, s74, v35
    v_dot2_f32_bf16 v36, v94, s67, v36
    v_dot2_f32_bf16 v37, v94, s74, v37
    v_dot2_f32_bf16 v38, v95, s67, v38
    v_dot2_f32_bf16 v39, v95, s74, v39
    s_nop 2
    v_permlane16_swap_b32 v32, v33
    v_permlane16_swap_b32 v34, v35
    v_add_f32 v32, v32, v33
    v_add_f32 v34, v34, v35
    s_nop 1
    v_permlane32_swap_b32 v32, v34
    v_add_f32 v32, v32, v34
    s_nop 2
    v_permlane16_swap_b32 v36, v37
    v_permlane16_swap_b32 v38, v39
    v_add_f32 v36, v36, v37
    v_add_f32 v38, v38, v39
    s_nop 1
    v_permlane32_swap_b32 v36, v38
    v_add_f32 v36, v36, v38
    v_and_b32 v13, 15, v1
    v_lshlrev_b32 v13, 5, v13
    v_lshrrev_b32 v15, 4, v1
    v_lshl_add_u32 v13, v15, 2, v13
    s_lshl_b32 s69, s3, 11
    v_add_u32 v13, s69, v13
    ds_write_b32 v13, v32 offset:512
    ds_write_b32 v13, v36 offset:528
    s_sleep 2
    s_cmp_lg_u32 s7, 0
    s_cbranch_scc1 L_30
    s_sleep 12
L_30:
POLL_28:
    s_add_u32 s68, s71, s62
    s_add_u32 s69, s68, 0
    buffer_load_dword v24, v10, s[16:19], s69 offen offset:2048 sc1
    s_add_u32 s69, s68, 32768
    buffer_load_dword v25, v10, s[16:19], s69 offen offset:2048 sc1
    s_add_u32 s69, s68, 65536
    buffer_load_dword v26, v10, s[16:19], s69 offen offset:2048 sc1
    s_add_u32 s69, s68, 98304
    buffer_load_dword v27, v10, s[16:19], s69 offen offset:2048 sc1
    s_add_u32 s69, s68, 131072
    buffer_load_dword v28, v10, s[16:19], s69 offen offset:2048 sc1
    s_add_u32 s69, s68, 163840
    buffer_load_dword v29, v10, s[16:19], s69 offen offset:2048 sc1
    s_add_u32 s69, s68, 196608
    buffer_load_dword v30, v10, s[16:19], s69 offen offset:2048 sc1
    s_add_u32 s69, s68, 229376
    buffer_load_dword v31, v10, s[16:19], s69 offen offset:2048 sc1
    s_waitcnt vmcnt(0)
    v_max_u32 v15, v24, v25
    v_max3_u32 v15, v15, v26, v27
    v_max3_u32 v15, v15, v28, v29
    v_max3_u32 v15, v15, v30, v31
    v_cmp_eq_u32 vcc, -1, v15
    s_cbranch_vccz PDONE_29
    s_cmp_eq_u32 s65, 0
    s_cbranch_scc1 PDONE_29
    s_sub_u32 s65, s65, 1
    s_branch POLL_28
PDONE_29:
    v_add_f32 v16, v24, v25
    v_add_f32 v18, v26, v27
    v_add_f32 v20, v28, v29
    v_add_f32 v22, v30, v31
    v_add_f32 v16, v16, v18
    v_add_f32 v20, v20, v22
    v_add_f32 v16, v16, v20
    v_mov_b32 v17, 1.0
    s_nop 1
    v_mfma_f32_16x16x4_f32 v[20:23], v16, v17, 0
    s_nop 7
    s_nop 3
    v_cvt_pk_bf16_f32 v20, v20, v20
    v_lshlrev_b32 v20, 16, v20
    v_add_f32 v4, v4, v20
    v_cvt_pk_bf16_f32 v4, v4, v4
    v_lshlrev_b32 v4, 16, v4
    v_cvt_pk_bf16_f32 v21, v21, v21
    v_lshlrev_b32 v21, 16, v21
    v_add_f32 v5, v5, v21
    v_cvt_pk_bf16_f32 v5, v5, v5
    v_lshlrev_b32 v5, 16, v5
    v_cvt_pk_bf16_f32 v22, v22, v22
    v_lshlrev_b32 v22, 16, v22
    v_add_f32 v6, v6, v22
    v_cvt_pk_bf16_f32 v6, v6, v6
    v_lshlrev_b32 v6, 16, v6
    v_cvt_pk_bf16_f32 v23, v23, v23
    v_lshlrev_b32 v23, 16, v23
    v_add_f32 v7, v7, v23
    v_cvt_pk_bf16_f32 v7, v7, v7
    v_lshlrev_b32 v7, 16, v7
    v_lshrrev_b32 v13, 4, v1
    v_lshlrev_b32 v13, 4, v13
    s_lshl_b32 s69, s3, 6
    s_add_u32 s69, s69, s63
    s_add_u32 s69, s69, s62
    s_mov_b64 exec, s[54:55]
    buffer_store_dwordx4 v[4:7], v13, s[16:19], s69 offen offset:3328 sc1
    s_mov_b64 exec, -1
    v_cvt_pk_bf16_f32 v24, v4, 0
    v_and_b32 v25, 0xffff0000, v4
    v_cvt_pk_bf16_f32 v26, v5, 0
    v_and_b32 v27, 0xffff0000, v5
    v_cvt_pk_bf16_f32 v28, v6, 0
    v_and_b32 v29, 0xffff0000, v6
    v_cvt_pk_bf16_f32 v30, v7, 0
    v_and_b32 v31, 0xffff0000, v7
    v_dot2_f32_bf16 v16, v80, v24, 0
    v_dot2_f32_bf16 v17, v80, v25, 0
    v_dot2_f32_bf16 v18, v81, v24, 0
    v_dot2_f32_bf16 v19, v81, v25, 0
    v_dot2_f32_bf16 v20, v82, v24, 0
    v_dot2_f32_bf16 v21, v82, v25, 0
    v_dot2_f32_bf16 v22, v83, v24, 0
    v_dot2_f32_bf16 v23, v83, v25, 0
    v_dot2_f32_bf16 v16, v84, v26, v16
    v_dot2_f32_bf16 v17, v84, v27, v17
    v_dot2_f32_bf16 v18, v85, v26, v18
    v_dot2_f32_bf16 v19, v85, v27, v19
    v_dot2_f32_bf16 v20, v86, v26, v20
    v_dot2_f32_bf16 v21, v86, v27, v21
    v_dot2_f32_bf16 v22, v87, v26, v22
    v_dot2_f32_bf16 v23, v87, v27, v23
    v_dot2_f32_bf16 v16, v88, v28, v16
    v_dot2_f32_bf16 v17, v88, v29, v17
    v_dot2_f32_bf16 v18, v89, v28, v18
    v_dot2_f32_bf16 v19, v89, v29, v19
    v_dot2_f32_bf16 v20, v90, v28, v20
    v_dot2_f32_bf16 v21, v90, v29, v21
    v_dot2_f32_bf16 v22, v91, v28, v22
    v_dot2_f32_bf16 v23, v91, v29, v23
    v_dot2_f32_bf16 v16, v92, v30, v16
    v_dot2_f32_bf16 v17, v92, v31, v17
    v_dot2_f32_bf16 v18, v93, v30, v18
    v_dot2_f32_bf16 v19, v93, v31, v19
    v_dot2_f32_bf16 v20, v94, v30, v20
    v_dot2_f32_bf16 v21, v94, v31, v21
    v_dot2_f32_bf16 v22, v95, v30, v22
    v_dot2_f32_bf16 v23, v95, v31, v23
    s_nop 2
    v_permlane16_swap_b32 v16, v17
    v_permlane16_swap_b32 v18, v19
    v_add_f32 v16, v16, v17
    v_add_f32 v18, v18, v19
    s_nop 1
    v_permlane32_swap_b32 v16, v18
    v_add_f32 v16, v16, v18
    s_nop 2
    v_permlane16_swap_b32 v20, v21
    v_permlane16_swap_b32 v22, v23
    v_add_f32 v20, v20, v21
    v_add_f32 v22, v22, v23
    s_nop 1
    v_permlane32_swap_b32 v20, v22
    v_add_f32 v20, v20, v22
    v_and_b32 v13, 15, v1
    v_lshlrev_b32 v13, 5, v13
    v_lshrrev_b32 v15, 4, v1
    v_lshl_add_u32 v13, v15, 2, v13
    s_lshl_b32 s69, s3, 11
    v_add_u32 v13, s69, v13
    ds_write_b32 v13, v16
    ds_write_b32 v13, v20 offset:16
    s_waitcnt lgkmcnt(0)
    s_barrier
    s_add_u32 s69, s63, s62
    s_cmp_ge_u32 s3, 1
    s_cbranch_scc1 L_31
    v_lshlrev_b32 v13, 2, v0
    ds_read_b32 v16, v13 offset:0
    ds_read_b32 v17, v13 offset:2048
    ds_read_b32 v18, v13 offset:4096
    ds_read_b32 v19, v13 offset:6144
    ds_read_b32 v20, v13 offset:256
    ds_read_b32 v21, v13 offset:2304
    ds_read_b32 v22, v13 offset:4352
    ds_read_b32 v23, v13 offset:6400
    ds_read_b32 v24, v13 offset:512
    ds_read_b32 v25, v13 offset:2560
    ds_read_b32 v26, v13 offset:4608
    ds_read_b32 v27, v13 offset:6656
    ds_read_b32 v28, v13 offset:768
    ds_read_b32 v29, v13 offset:2816
    ds_read_b32 v30, v13 offset:4864
    ds_read_b32 v31, v13 offset:6912
    v_lshlrev_b32 v13, 4, v0
    s_waitcnt lgkmcnt(0)
    v_add_f32 v16, v16, v17
    v_add_f32 v18, v18, v19
    v_add_f32 v32, v16, v18
    v_add_f32 v20, v20, v21
    v_add_f32 v22, v22, v23
    v_add_f32 v33, v20, v22
    v_add_f32 v24, v24, v25
    v_add_f32 v26, v26, v27
    v_add_f32 v34, v24, v26
    v_add_f32 v28, v28, v29
    v_add_f32 v30, v30, v31
    v_add_f32 v35, v28, v30
    buffer_store_dwordx4 v[32:35], v13, s[16:19], s69 offen offset:2304 sc1
L_31:
    s_cmp_ge_u32 s3, 1
    s_cbranch_scc1 L_32
    s_sleep 8
POLL_33:
    v_lshrrev_b32 v14, 3, v1
    v_lshlrev_b32 v14, 18, v14
    v_and_b32 v15, 7, v1
    v_lshl_add_u32 v14, v15, 5, v14
    s_add_u32 s68, s70, s62
    buffer_load_dwordx4 v[56:59], v14, s[16:19], s68 offen offset:3328 sc1
    buffer_load_dwordx4 v[60:63], v14, s[16:19], s68 offen offset:3344 sc1
    v_lshlrev_b32 v13, 4, v0
    s_add_u32 s69, s68, 0
    buffer_load_dwordx4 v[16:19], v13, s[16:19], s69 offen offset:2304 sc1
    s_add_u32 s69, s68, 262144
    buffer_load_dwordx4 v[20:23], v13, s[16:19], s69 offen offset:2304 sc1
    s_add_u32 s69, s68, 524288
    buffer_load_dwordx4 v[24:27], v13, s[16:19], s69 offen offset:2304 sc1
    s_add_u32 s69, s68, 786432
    buffer_load_dwordx4 v[28:31], v13, s[16:19], s69 offen offset:2304 sc1
    s_add_u32 s69, s68, 1048576
    buffer_load_dwordx4 v[32:35], v13, s[16:19], s69 offen offset:2304 sc1
    s_add_u32 s69, s68, 1310720
    buffer_load_dwordx4 v[36:39], v13, s[16:19], s69 offen offset:2304 sc1
    s_add_u32 s69, s68, 1572864
    buffer_load_dwordx4 v[40:43], v13, s[16:19], s69 offen offset:2304 sc1
    s_add_u32 s69, s68, 1835008
    buffer_load_dwordx4 v[44:47], v13, s[16:19], s69 offen offset:2304 sc1
    s_waitcnt vmcnt(0)
    v_max_u32 v15, v16, v17
    v_max3_u32 v15, v15, v18, v19
    v_max3_u32 v15, v15, v20, v21
    v_max3_u32 v15, v15, v22, v23
    v_max3_u32 v15, v15, v24, v25
    v_max3_u32 v15, v15, v26, v27
    v_max3_u32 v15, v15, v28, v29
    v_max3_u32 v15, v15, v30, v31
    v_max3_u32 v15, v15, v32, v33
    v_max3_u32 v15, v15, v34, v35
    v_max3_u32 v15, v15, v36, v37
    v_max3_u32 v15, v15, v38, v39
    v_max3_u32 v15, v15, v40, v41
    v_max3_u32 v15, v15, v42, v43
    v_max3_u32 v15, v15, v44, v45
    v_max3_u32 v15, v15, v46, v47
    v_max3_u32 v15, v15, v56, v57
    v_max3_u32 v15, v15, v58, v59
    v_max3_u32 v15, v15, v60, v61
    v_max3_u32 v15, v15, v62, v63
    v_cmp_eq_u32 vcc, -1, v15
    s_cbranch_vccz PDONE_34
    s_cmp_eq_u32 s65, 0
    s_cbranch_scc1 PDONE_34
    s_sub_u32 s65, s65, 1
    s_branch POLL_33
PDONE_34:
    v_add_f32 v13, v56, v57
    v_add_f32 v13, v13, v58
    v_add_f32 v13, v13, v59
    v_add_f32 v13, v13, v60
    v_add_f32 v13, v13, v61
    v_add_f32 v13, v13, v62
    v_add_f32 v13, v13, v63
    s_nop 1
    v_add_f32_dpp v13, v13, v13 quad_perm:[1,0,3,2] row_mask:0xf bank_mask:0xf
    s_nop 1
    v_add_f32_dpp v13, v13, v13 quad_perm:[2,3,0,1] row_mask:0xf bank_mask:0xf
    s_nop 1
    v_add_f32_dpp v13, v13, v13 row_half_mirror row_mask:0xf bank_mask:0xf
    s_nop 1
    v_add_f32_dpp v13, v13, v13 row_mirror row_mask:0xf bank_mask:0xf
    v_mov_b32 v15, v13
    s_nop 1
    v_permlane16_swap_b32 v15, v13
    v_add_f32 v13, v15, v13
    v_mov_b32 v15, v13
    s_nop 1
    v_permlane32_swap_b32 v15, v13
    v_add_f32 v13, v15, v13
    v_mul_f32 v13, 0x3b000000, v13
    v_sub_f32 v56, v56, v13
    v_sub_f32 v57, v57, v13
    v_sub_f32 v58, v58, v13
    v_sub_f32 v59, v59, v13
    v_sub_f32 v60, v60, v13
    v_sub_f32 v61, v61, v13
    v_sub_f32 v62, v62, v13
    v_sub_f32 v63, v63, v13
    v_mul_f32 v14, v56, v56
    v_fmac_f32 v14, v57, v57
    v_fmac_f32 v14, v58, v58
    v_fmac_f32 v14, v59, v59
    v_fmac_f32 v14, v60, v60
    v_fmac_f32 v14, v61, v61
    v_fmac_f32 v14, v62, v62
    v_fmac_f32 v14, v63, v63
    s_nop 1
    v_add_f32_dpp v14, v14, v14 quad_perm:[1,0,3,2] row_mask:0xf bank_mask:0xf
    s_nop 1
    v_add_f32_dpp v14, v14, v14 quad_perm:[2,3,0,1] row_mask:0xf bank_mask:0xf
    s_nop 1
    v_add_f32_dpp v14, v14, v14 row_half_mirror row_mask:0xf bank_mask:0xf
    s_nop 1
    v_add_f32_dpp v14, v14, v14 row_mirror row_mask:0xf bank_mask:0xf
    v_mov_b32 v15, v14
    s_nop 1
    v_permlane16_swap_b32 v15, v14
    v_add_f32 v14, v15, v14
    v_mov_b32 v15, v14
    s_nop 1
    v_permlane32_swap_b32 v15, v14
    v_add_f32 v14, v15, v14
    v_mov_b32 v15, 0x3727c5ac
    v_fmac_f32 v15, 0x3b000000, v14
    v_rsq_f32 v14, v15
    s_nop 0
    v_add_f32 v16, v16, v20
    v_add_f32 v17, v17, v21
    v_add_f32 v18, v18, v22
    v_add_f32 v19, v19, v23
    v_add_f32 v16, v16, v24
    v_add_f32 v17, v17, v25
    v_add_f32 v18, v18, v26
    v_add_f32 v19, v19, v27
    v_add_f32 v16, v16, v28
    v_add_f32 v17, v17, v29
    v_add_f32 v18, v18, v30
    v_add_f32 v19, v19, v31
    v_add_f32 v16, v16, v32
    v_add_f32 v17, v17, v33
    v_add_f32 v18, v18, v34
    v_add_f32 v19, v19, v35
    v_add_f32 v16, v16, v36
    v_add_f32 v17, v17, v37
    v_add_f32 v18, v18, v38
    v_add_f32 v19, v19, v39
    v_add_f32 v16, v16, v40
    v_add_f32 v17, v17, v41
    v_add_f32 v18, v18, v42
    v_add_f32 v19, v19, v43
    v_add_f32 v16, v16, v44
    v_add_f32 v17, v17, v45
    v_add_f32 v18, v18, v46
    v_add_f32 v19, v19, v47
    v_fma_f32 v16, -v13, v18, v16
    v_fma_f32 v17, -v13, v19, v17
    v_mul_f32 v16, v16, v14
    v_mul_f32 v17, v17, v14
    v_cvt_pk_bf16_f32 v16, v16, v16
    v_lshlrev_b32 v16, 16, v16
    v_cvt_pk_bf16_f32 v17, v17, v17
    v_lshlrev_b32 v17, 16, v17
    v_mul_f32 v16, 0xbfb8aa3b, v16
    v_exp_f32 v16, v16
    s_nop 0
    v_add_f32 v16, 1.0, v16
    v_rcp_f32 v16, v16
    s_nop 0
    v_cvt_pk_bf16_f32 v16, v16, v16
    v_lshlrev_b32 v16, 16, v16
    v_mul_f32 v16, v16, v17
    v_cvt_pk_bf16_f32 v16, v16, 0
    v_cmp_gt_u32 vcc, s73, v0
    s_nop 1
    v_cndmask_b32 v16, 0, v16, vcc
    v_bfe_u32 v13, v0, 2, 2
    v_lshlrev_b32 v13, 4, v13
    v_and_b32 v14, 3, v0
    v_lshl_add_u32 v13, v14, 2, v13
    v_lshrrev_b32 v14, 4, v0
    v_add_lshl_u32 v13, v13, v14, 2
    ds_write_b32 v13, v16 offset:8704
L_32:
    s_waitcnt lgkmcnt(0)
    s_barrier
    v_lshrrev_b32 v13, 4, v1
    v_lshlrev_b32 v13, 4, v13
    s_lshl_b32 s69, s3, 6
    v_add_u32 v13, s69, v13
    ds_read_b128 v[16:19], v13 offset:8704
    s_waitcnt lgkmcnt(0)
    v_lshlrev_b32 v24, 16, v16
    v_lshlrev_b32 v25, 16, v17
    v_lshlrev_b32 v26, 16, v18
    v_dot2_f32_bf16 v32, v48, v16, 0
    v_dot2_f32_bf16 v33, v48, v24, 0
    v_dot2_f32_bf16 v34, v49, v16, 0
    v_dot2_f32_bf16 v35, v49, v24, 0
    v_dot2_f32_bf16 v32, v50, v17, v32
    v_dot2_f32_bf16 v33, v50, v25, v33
    v_dot2_f32_bf16 v34, v51, v17, v34
    v_dot2_f32_bf16 v35, v51, v25, v35
    v_dot2_f32_bf16 v32, v52, v18, v32
    v_dot2_f32_bf16 v33, v52, v26, v33
    v_dot2_f32_bf16 v34, v53, v18, v34
    v_dot2_f32_bf16 v35, v53, v26, v35
    s_nop 2
    v_permlane16_swap_b32 v32, v33
    v_permlane16_swap_b32 v34, v35
    v_add_f32 v32, v32, v33
    v_add_f32 v34, v34, v35
    s_nop 1
    v_permlane32_swap_b32 v32, v34
    v_add_f32 v32, v32, v34
    v_and_b32 v13, 15, v1
    v_lshlrev_b32 v13, 4, v13
    v_lshrrev_b32 v15, 4, v1
    v_lshl_add_u32 v13, v15, 2, v13
    s_lshl_b32 s69, s3, 11
    v_add_u32 v13, s69, v13
    ds_write_b32 v13, v32 offset:1024
    s_waitcnt lgkmcnt(0)
    s_barrier
    s_cmp_ge_u32 s3, 1
    s_cbranch_scc1 L_35
    v_lshlrev_b32 v13, 2, v0
    ds_read_b32 v16, v13 offset:1024
    ds_read_b32 v17, v13 offset:3072
    ds_read_b32 v18, v13 offset:5120
    ds_read_b32 v19, v13 offset:7168
    s_add_u32 s69, s63, s62
    s_waitcnt lgkmcnt(0)
    v_add_f32 v16, v16, v17
    v_add_f32 v18, v18, v19
    v_add_f32 v16, v16, v18
    s_cmp_lg_u32 s7, 0
    s_cbranch_scc1 L_36
    buffer_store_dword v16, v13, s[16:19], s69 offen offset:3584 sc1
    s_branch L_37
L_36:
    buffer_store_dword v16, v13, s[16:19], s69 offen offset:3584
L_37:
L_35:
    s_cmp_lg_u32 s62, 0
    s_cbranch_scc1 FIN_38
    v_lshrrev_b32 v40, 4, v1
    v_lshlrev_b32 v40, 15, v40
    v_and_b32 v15, 15, v1
    v_lshl_add_u32 v40, v15, 4, v40
    s_add_u32 s69, s75, 0
    buffer_load_dwordx4 v[96:99], v40, s[20:23], s69 offen nt
    s_add_u32 s69, s75, 8192
    buffer_load_dwordx4 v[100:103], v40, s[20:23], s69 offen nt
    s_add_u32 s69, s75, 16384
    buffer_load_dwordx4 v[104:107], v40, s[20:23], s69 offen nt
    s_add_u32 s69, s75, 24576
    buffer_load_dwordx4 v[108:111], v40, s[20:23], s69 offen nt
    s_sleep 2
    s_cmp_lg_u32 s7, 0
    s_cbranch_scc1 L_41
    s_sleep 12
L_41:
POLL_39:
    s_add_u32 s68, s71, s62
    s_add_u32 s69, s68, 0
    buffer_load_dword v24, v10, s[16:19], s69 offen offset:3584 sc1
    s_add_u32 s69, s68, 32768
    buffer_load_dword v25, v10, s[16:19], s69 offen offset:3584 sc1
    s_add_u32 s69, s68, 65536
    buffer_load_dword v26, v10, s[16:19], s69 offen offset:3584 sc1
    s_add_u32 s69, s68, 98304
    buffer_load_dword v27, v10, s[16:19], s69 offen offset:3584 sc1
    s_add_u32 s69, s68, 131072
    buffer_load_dword v28, v10, s[16:19], s69 offen offset:3584 sc1
    s_add_u32 s69, s68, 163840
    buffer_load_dword v29, v10, s[16:19], s69 offen offset:3584 sc1
    s_add_u32 s69, s68, 196608
    buffer_load_dword v30, v10, s[16:19], s69 offen offset:3584 sc1
    s_add_u32 s69, s68, 229376
    buffer_load_dword v31, v10, s[16:19], s69 offen offset:3584 sc1
    s_waitcnt vmcnt(0)
    v_max_u32 v15, v24, v25
    v_max3_u32 v15, v15, v26, v27
    v_max3_u32 v15, v15, v28, v29
    v_max3_u32 v15, v15, v30, v31
    v_cmp_eq_u32 vcc, -1, v15
    s_cbranch_vccz PDONE_40
    s_cmp_eq_u32 s65, 0
    s_cbranch_scc1 PDONE_40
    s_sub_u32 s65, s65, 1
    s_branch POLL_39
PDONE_40:
    v_add_f32 v16, v24, v25
    v_add_f32 v18, v26, v27
    v_add_f32 v20, v28, v29
    v_add_f32 v22, v30, v31
    v_add_f32 v16, v16, v18
    v_add_f32 v20, v20, v22
    v_add_f32 v16, v16, v20
    v_mov_b32 v17, 1.0
    s_nop 1
    v_mfma_f32_16x16x4_f32 v[20:23], v16, v17, 0
    s_nop 7
    s_nop 3
    v_cvt_pk_bf16_f32 v20, v20, v20
    v_lshlrev_b32 v20, 16, v20
    v_add_f32 v4, v4, v20
    v_cvt_pk_bf16_f32 v4, v4, v4
    v_lshlrev_b32 v4, 16, v4
    v_cvt_pk_bf16_f32 v21, v21, v21
    v_lshlrev_b32 v21, 16, v21
    v_add_f32 v5, v5, v21
    v_cvt_pk_bf16_f32 v5, v5, v5
    v_lshlrev_b32 v5, 16, v5
    v_cvt_pk_bf16_f32 v22, v22, v22
    v_lshlrev_b32 v22, 16, v22
    v_add_f32 v6, v6, v22
    v_cvt_pk_bf16_f32 v6, v6, v6
    v_lshlrev_b32 v6, 16, v6
    v_cvt_pk_bf16_f32 v23, v23, v23
    v_lshlrev_b32 v23, 16, v23
    v_add_f32 v7, v7, v23
    v_cvt_pk_bf16_f32 v7, v7, v7
    v_lshlrev_b32 v7, 16, v7
    s_mov_b32 s62, 4096
    v_lshrrev_b32 v13, 4, v1
    v_lshlrev_b32 v13, 4, v13
    s_lshl_b32 s69, s3, 6
    s_add_u32 s69, s69, s63
    s_add_u32 s69, s69, s62
    s_mov_b64 exec, s[54:55]
    buffer_store_dwordx4 v[4:7], v13, s[16:19], s69 offen offset:1024 sc1
    s_mov_b64 exec, -1
    v_cvt_pk_bf16_f32 v24, v4, 0
    v_and_b32 v25, 0xffff0000, v4
    v_cvt_pk_bf16_f32 v26, v5, 0
    v_and_b32 v27, 0xffff0000, v5
    v_cvt_pk_bf16_f32 v28, v6, 0
    v_and_b32 v29, 0xffff0000, v6
    v_cvt_pk_bf16_f32 v30, v7, 0
    v_and_b32 v31, 0xffff0000, v7
    v_dot2_f32_bf16 v16, v96, v24, 0
    v_dot2_f32_bf16 v17, v96, v25, 0
    v_dot2_f32_bf16 v18, v97, v24, 0
    v_dot2_f32_bf16 v19, v97, v25, 0
    v_dot2_f32_bf16 v20, v98, v24, 0
    v_dot2_f32_bf16 v21, v98, v25, 0
    v_dot2_f32_bf16 v22, v99, v24, 0
    v_dot2_f32_bf16 v23, v99, v25, 0
    v_dot2_f32_bf16 v16, v100, v26, v16
    v_dot2_f32_bf16 v17, v100, v27, v17
    v_dot2_f32_bf16 v18, v101, v26, v18
    v_dot2_f32_bf16 v19, v101, v27, v19
    v_dot2_f32_bf16 v20, v102, v26, v20
    v_dot2_f32_bf16 v21, v102, v27, v21
    v_dot2_f32_bf16 v22, v103, v26, v22
    v_dot2_f32_bf16 v23, v103, v27, v23
    v_dot2_f32_bf16 v16, v104, v28, v16
    v_dot2_f32_bf16 v17, v104, v29, v17
    v_dot2_f32_bf16 v18, v105, v28, v18
    v_dot2_f32_bf16 v19, v105, v29, v19
    v_dot2_f32_bf16 v20, v106, v28, v20
    v_dot2_f32_bf16 v21, v106, v29, v21
    v_dot2_f32_bf16 v22, v107, v28, v22
    v_dot2_f32_bf16 v23, v107, v29, v23
    v_dot2_f32_bf16 v16, v108, v30, v16
    v_dot2_f32_bf16 v17, v108, v31, v17
    v_dot2_f32_bf16 v18, v109, v30, v18
    v_dot2_f32_bf16 v19, v109, v31, v19
    v_dot2_f32_bf16 v20, v110, v30, v20
    v_dot2_f32_bf16 v21, v110, v31, v21
    v_dot2_f32_bf16 v22, v111, v30, v22
    v_dot2_f32_bf16 v23, v111, v31, v23
    s_nop 2
    v_permlane16_swap_b32 v16, v17
    v_permlane16_swap_b32 v18, v19
    v_add_f32 v16, v16, v17
    v_add_f32 v18, v18, v19
    s_nop 1
    v_permlane32_swap_b32 v16, v18
    v_add_f32 v16, v16, v18
    s_nop 2
    v_permlane16_swap_b32 v20, v21
    v_permlane16_swap_b32 v22, v23
    v_add_f32 v20, v20, v21
    v_add_f32 v22, v22, v23
    s_nop 1
    v_permlane32_swap_b32 v20, v22
    v_add_f32 v20, v20, v22
    v_and_b32 v13, 15, v1
    v_lshlrev_b32 v13, 5, v13
    v_lshrrev_b32 v15, 4, v1
    v_lshl_add_u32 v13, v15, 2, v13
    s_lshl_b32 s69, s3, 11
    v_add_u32 v13, s69, v13
    ds_write_b32 v13, v16
    ds_write_b32 v13, v20 offset:16
    s_waitcnt lgkmcnt(0)
    s_barrier
    s_add_u32 s69, s63, s62
    s_cmp_ge_u32 s3, 2
    s_cbranch_scc1 L_42
    v_lshlrev_b32 v13, 2, v0
    ds_read_b32 v16, v13 offset:0
    ds_read_b32 v20, v13 offset:512
    ds_read_b32 v17, v13 offset:2048
    ds_read_b32 v21, v13 offset:2560
    ds_read_b32 v18, v13 offset:4096
    ds_read_b32 v22, v13 offset:4608
    ds_read_b32 v19, v13 offset:6144
    ds_read_b32 v23, v13 offset:6656
    v_lshlrev_b32 v13, 3, v0
    s_waitcnt lgkmcnt(0)
    v_add_f32 v16, v16, v17
    v_add_f32 v18, v18, v19
    v_add_f32 v24, v16, v18
    v_add_f32 v20, v20, v21
    v_add_f32 v22, v22, v23
    v_add_f32 v25, v20, v22
    buffer_store_dwordx2 v[24:25], v13, s[16:19], s69 offen offset:0 sc1
L_42:
    s_cmp_ge_u32 s3, 2
    s_cbranch_scc1 L_43
    s_sleep 8
POLL_44:
    v_lshrrev_b32 v14, 3, v1
    v_lshlrev_b32 v14, 18, v14
    v_and_b32 v15, 7, v1
    v_lshl_add_u32 v14, v15, 5, v14
    s_add_u32 s68, s70, s62
    buffer_load_dwordx4 v[32:35], v14, s[16:19], s68 offen offset:1024 sc1
    buffer_load_dwordx4 v[36:39], v14, s[16:19], s68 offen offset:1040 sc1
    v_lshlrev_b32 v13, 3, v0
    s_add_u32 s69, s68, 0
    buffer_load_dwordx2 v[16:17], v13, s[16:19], s69 offen offset:0 sc1
    s_add_u32 s69, s68, 262144
    buffer_load_dwordx2 v[18:19], v13, s[16:19], s69 offen offset:0 sc1
    s_add_u32 s69, s68, 524288
    buffer_load_dwordx2 v[20:21], v13, s[16:19], s69 offen offset:0 sc1
    s_add_u32 s69, s68, 786432
    buffer_load_dwordx2 v[22:23], v13, s[16:19], s69 offen offset:0 sc1
    s_add_u32 s69, s68, 1048576
    buffer_load_dwordx2 v[24:25], v13, s[16:19], s69 offen offset:0 sc1
    s_add_u32 s69, s68, 1310720
    buffer_load_dwordx2 v[26:27], v13, s[16:19], s69 offen offset:0 sc1
    s_add_u32 s69, s68, 1572864
    buffer_load_dwordx2 v[28:29], v13, s[16:19], s69 offen offset:0 sc1
    s_add_u32 s69, s68, 1835008
    buffer_load_dwordx2 v[30:31], v13, s[16:19], s69 offen offset:0 sc1
    s_waitcnt vmcnt(0)
    v_max_u32 v15, v16, v17
    v_max3_u32 v15, v15, v18, v19
    v_max3_u32 v15, v15, v20, v21
    v_max3_u32 v15, v15, v22, v23
    v_max3_u32 v15, v15, v24, v25
    v_max3_u32 v15, v15, v26, v27
    v_max3_u32 v15, v15, v28, v29
    v_max3_u32 v15, v15, v30, v31
    v_max3_u32 v15, v15, v32, v33
    v_max3_u32 v15, v15, v34, v35
    v_max3_u32 v15, v15, v36, v37
    v_max3_u32 v15, v15, v38, v39
    v_cmp_eq_u32 vcc, -1, v15
    s_cbranch_vccz PDONE_45
    s_cmp_eq_u32 s65, 0
    s_cbranch_scc1 PDONE_45
    s_sub_u32 s65, s65, 1
    s_branch POLL_44
PDONE_45:
    v_lshlrev_b32 v41, 2, v0
    ds_read_b32 v40, v41 offset:9216
    v_add_f32 v13, v32, v33
    v_add_f32 v13, v13, v34
    v_add_f32 v13, v13, v35
    v_add_f32 v13, v13, v36
    v_add_f32 v13, v13, v37
    v_add_f32 v13, v13, v38
    v_add_f32 v13, v13, v39
    s_nop 1
    v_add_f32_dpp v13, v13, v13 quad_perm:[1,0,3,2] row_mask:0xf bank_mask:0xf
    s_nop 1
    v_add_f32_dpp v13, v13, v13 quad_perm:[2,3,0,1] row_mask:0xf bank_mask:0xf
    s_nop 1
    v_add_f32_dpp v13, v13, v13 row_half_mirror row_mask:0xf bank_mask:0xf
    s_nop 1
    v_add_f32_dpp v13, v13, v13 row_mirror row_mask:0xf bank_mask:0xf
    v_mov_b32 v15, v13
    s_nop 1
    v_permlane16_swap_b32 v15, v13
    v_add_f32 v13, v15, v13
    v_mov_b32 v15, v13
    s_nop 1
    v_permlane32_swap_b32 v15, v13
    v_add_f32 v13, v15, v13
    v_mul_f32 v13, 0x3b000000, v13
    v_sub_f32 v32, v32, v13
    v_sub_f32 v33, v33, v13
    v_sub_f32 v34, v34, v13
    v_sub_f32 v35, v35, v13
    v_sub_f32 v36, v36, v13
    v_sub_f32 v37, v37, v13
    v_sub_f32 v38, v38, v13
    v_sub_f32 v39, v39, v13
    v_mul_f32 v14, v32, v32
    v_fmac_f32 v14, v33, v33
    v_fmac_f32 v14, v34, v34
    v_fmac_f32 v14, v35, v35
    v_fmac_f32 v14, v36, v36
    v_fmac_f32 v14, v37, v37
    v_fmac_f32 v14, v38, v38
    v_fmac_f32 v14, v39, v39
    s_nop 1
    v_add_f32_dpp v14, v14, v14 quad_perm:[1,0,3,2] row_mask:0xf bank_mask:0xf
    s_nop 1
    v_add_f32_dpp v14, v14, v14 quad_perm:[2,3,0,1] row_mask:0xf bank_mask:0xf
    s_nop 1
    v_add_f32_dpp v14, v14, v14 row_half_mirror row_mask:0xf bank_mask:0xf
    s_nop 1
    v_add_f32_dpp v14, v14, v14 row_mirror row_mask:0xf bank_mask:0xf
    v_mov_b32 v15, v14
    s_nop 1
    v_permlane16_swap_b32 v15, v14
    v_add_f32 v14, v15, v14
    v_mov_b32 v15, v14
    s_nop 1
    v_permlane32_swap_b32 v15, v14
    v_add_f32 v14, v15, v14
    v_mov_b32 v15, 0x3727c5ac
    v_fmac_f32 v15, 0x3b000000, v14
    v_rsq_f32 v14, v15
    s_nop 0
    v_add_f32 v16, v16, v18
    v_add_f32 v16, v16, v20
    v_add_f32 v16, v16, v22
    v_add_f32 v16, v16, v24
    v_add_f32 v16, v16, v26
    v_add_f32 v16, v16, v28
    v_add_f32 v16, v16, v30
    s_waitcnt lgkmcnt(0)
    v_fma_f32 v16, -v13, v40, v16
    v_mul_f32 v16, v16, v14
    v_cvt_pk_bf16_f32 v16, v16, v16
    v_lshlrev_b32 v13, 1, v0
    ds_write_b16 v13, v16 offset:8960
L_43:
    s_waitcnt vmcnt(0)
    s_branch L_PASS
FIN_38:
    s_cmp_lg_u32 s4, 0
    s_cbranch_scc1 L_END
    s_sleep 2
    s_cmp_lg_u32 s7, 0
    s_cbranch_scc1 L_48
    s_sleep 12
L_48:
POLL_46:
    s_add_u32 s68, s71, s62
    s_add_u32 s69, s68, 0
    buffer_load_dword v24, v10, s[16:19], s69 offen offset:3584 sc1
    s_add_u32 s69, s68, 32768
    buffer_load_dword v25, v10, s[16:19], s69 offen offset:3584 sc1
    s_add_u32 s69, s68, 65536
    buffer_load_dword v26, v10, s[16:19], s69 offen offset:3584 sc1
    s_add_u32 s69, s68, 98304
    buffer_load_dword v27, v10, s[16:19], s69 offen offset:3584 sc1
    s_add_u32 s69, s68, 131072
    buffer_load_dword v28, v10, s[16:19], s69 offen offset:3584 sc1
    s_add_u32 s69, s68, 163840
    buffer_load_dword v29, v10, s[16:19], s69 offen offset:3584 sc1
    s_add_u32 s69, s68, 196608
    buffer_load_dword v30, v10, s[16:19], s69 offen offset:3584 sc1
    s_add_u32 s69, s68, 229376
    buffer_load_dword v31, v10, s[16:19], s69 offen offset:3584 sc1
    s_waitcnt vmcnt(0)
    v_max_u32 v15, v24, v25
    v_max3_u32 v15, v15, v26, v27
    v_max3_u32 v15, v15, v28, v29
    v_max3_u32 v15, v15, v30, v31
    v_cmp_eq_u32 vcc, -1, v15
    s_cbranch_vccz PDONE_47
    s_cmp_eq_u32 s65, 0
    s_cbranch_scc1 PDONE_47
    s_sub_u32 s65, s65, 1
    s_branch POLL_46
PDONE_47:
    v_add_f32 v16, v24, v25
    v_add_f32 v18, v26, v27
    v_add_f32 v20, v28, v29
    v_add_f32 v22, v30, v31
    v_add_f32 v16, v16, v18
    v_add_f32 v20, v20, v22
    v_add_f32 v16, v16, v20
    v_mov_b32 v17, 1.0
    s_nop 1
    v_mfma_f32_16x16x4_f32 v[20:23], v16, v17, 0
    s_nop 7
    s_nop 3
    v_cvt_pk_bf16_f32 v20, v20, v20
    v_lshlrev_b32 v20, 16, v20
    v_add_f32 v4, v4, v20
    v_cvt_pk_bf16_f32 v4, v4, v4
    v_lshlrev_b32 v4, 16, v4
    v_cvt_pk_bf16_f32 v21, v21, v21
    v_lshlrev_b32 v21, 16, v21
    v_add_f32 v5, v5, v21
    v_cvt_pk_bf16_f32 v5, v5, v5
    v_lshlrev_b32 v5, 16, v5
    v_cvt_pk_bf16_f32 v22, v22, v22
    v_lshlrev_b32 v22, 16, v22
    v_add_f32 v6, v6, v22
    v_cvt_pk_bf16_f32 v6, v6, v6
    v_lshlrev_b32 v6, 16, v6
    v_cvt_pk_bf16_f32 v23, v23, v23
    v_lshlrev_b32 v23, 16, v23
    v_add_f32 v7, v7, v23
    v_cvt_pk_bf16_f32 v7, v7, v7
    v_lshlrev_b32 v7, 16, v7
    v_cvt_pk_bf16_f32 v16, v4, v5
    v_cvt_pk_bf16_f32 v17, v6, v7
    v_lshrrev_b32 v13, 4, v1
    v_lshlrev_b32 v13, 3, v13
    s_lshl_b32 s68, s5, 7
    s_lshl_b32 s69, s3, 5
    s_add_u32 s68, s68, s69
    s_mov_b64 exec, s[54:55]
    buffer_store_dwordx2 v[16:17], v13, s[44:47], s68 offen
    s_mov_b64 exec, -1
L_END:
    s_endpgm
L_CODE_END:
.section .rodata,"a"
.p2align 6
.amdhsa_kernel interleave_layers__gqa_block_cached__glu_gated_glu__decode_kernel
  .amdhsa_next_free_vgpr 512
  .amdhsa_next_free_sgpr 102
  .amdhsa_accum_offset 256
  .amdhsa_group_segment_fixed_size 0
  .amdhsa_kernarg_size 96
  .amdhsa_user_sgpr_count 2
  .amdhsa_user_sgpr_kernarg_segment_ptr 1
  .amdhsa_system_sgpr_workgroup_id_x 1
.end_amdhsa_kernel
```
